```python
import torch

def _softmax(x, axis=-1):
    return torch.softmax(x, dim=axis)
def _gelu(x):
    return torch.nn.functional.gelu(x, approximate="tanh")
def _silu(x):
    return torch.nn.functional.silu(x)
def _sigmoid(x):
    return torch.sigmoid(x)
def _layernorm(x, axis=-1, eps=1e-5):
    m = x.mean(dim=axis, keepdim=True)
    v = x.var(dim=axis, keepdim=True, unbiased=False)
    return (x - m) / torch.sqrt(v + eps)
def _scatter_add(tgt, idx, src, axis=0):
    return tgt.clone().index_add_(axis, idx, src)
def _segment_sum(src, seg, n):
    out = torch.zeros((n,) + src.shape[1:], dtype=src.dtype)
    return out.index_add_(0, seg, src)
def _pad(x, pw):
    flat = tuple(v for pair in reversed(pw) for v in pair)
    return torch.nn.functional.pad(x, flat)

kernel_name = 'interleave_layers__ssm_conv_h3__linear_kernel_hedgehog__prompt'

def setup_inputs():

    _w = (lambda a: (lambda t: t.to(torch.bfloat16) if t.is_floating_point() else t)(torch.as_tensor(a)))
    def _A_setup():
        B, S, D = 1, 2048, 1024
        ks = 4
        return {
            "q": _w((lambda *s: torch.randn(*s, dtype=torch.bfloat16) * 0.05)(B, S, D)),
            "k": _w((lambda *s: torch.randn(*s, dtype=torch.bfloat16) * 0.4)(B, S, D)),
            "v": _w((lambda *s: torch.randn(*s, dtype=torch.bfloat16) * 0.4)(B, S, D)),
            "shift_k": _w((lambda *s: torch.randn(*s, dtype=torch.bfloat16) * 0.4)(D, ks) * 0.5),
            "ssm_k": _w((lambda *s: torch.randn(*s, dtype=torch.bfloat16) * 0.4)(D, S) * (1.0 / S ** 0.5)),
            "ssm_D": _w((lambda *s: torch.randn(*s, dtype=torch.bfloat16) * 0.4)(D)),
        }
    _A_in = _A_setup()

    def _B_setup():
        B, S, D, H = 1, 2048, 1024, 32
        Dh = D // H
        return {
            "x": _w((lambda *s: torch.randn(*s, dtype=torch.bfloat16) * 0.05)(B, S, D)),
            "wqkv": _w((lambda *s: torch.randn(*s, dtype=torch.bfloat16) * 0.2)(D, 3 * D)),
            "w_phi": _w((lambda *s: torch.randn(*s, dtype=torch.bfloat16) * 0.2)(H, Dh, Dh) * (Dh ** -0.5)),
            "wo": _w((lambda *s: torch.randn(*s, dtype=torch.bfloat16) * 0.05)(D, D)),
        }
    _B_in = _B_setup()

    return {
        "A_q": _A_in["q"],
        "A_k": _A_in["k"],
        "A_v": _A_in["v"],
        "A_shift_k": _A_in["shift_k"],
        "A_ssm_k": _A_in["ssm_k"],
        "A_ssm_D": _A_in["ssm_D"],
        "B_x": _B_in["x"],
        "B_wqkv": _B_in["wqkv"],
        "B_w_phi": _B_in["w_phi"],
        "B_wo": _B_in["wo"],
    }

def reference(A_q, A_k, A_v, A_shift_k, A_ssm_k, A_ssm_D, B_x, B_wqkv, B_w_phi, B_wo):
    def _A_ref(q, k, v, shift_k, ssm_k, ssm_D):
        B, S, D = q.shape
        ks = shift_k.shape[-1]
        k_pad = _pad(k, ((0, 0), (ks - 1, 0), (0, 0)))
        k_shift = torch.zeros_like(k)
        for t in range(ks):
            k_shift = k_shift + k_pad[:, t:t + S, :] * shift_k[:, ks - 1 - t][None, None, :]
        kv = k_shift * v
        L = 2 * S
        kv_pad = _pad(kv, ((0, 0), (0, S), (0, 0)))
        kf_pad = _pad(ssm_k, ((0, 0), (0, S)))
        kv_f = (lambda x, axes=(-2,-1): torch.fft.rfft2(x.float(), dim=axes))(kv_pad[:, None, :, :], axes=(1, 2))
        kf_f = (lambda x, axes=(-2,-1): torch.fft.rfft2(x.float(), dim=axes))(kf_pad[:, None, :], axes=(1, 2))
        kf_f = (lambda x, *d: x.permute(*d))(kf_f, 1, 2, 0)
        y_f = kv_f * kf_f[None, :, :, :]
        y = (lambda x, s, axes=(-2,-1): torch.fft.irfft2(x, s=s, dim=axes).to(torch.bfloat16))(y_f, (1, L), axes=(1, 2))[:, 0, :S, :]
        y = y + kv * ssm_D[None, None, :]
        return q * y

    def _B_ref(x, wqkv, w_phi, wo):
        B, S, D = x.shape
        H = 32; Dh = D // H
        qkv = (lambda x, *d: x.permute(*d))((x @ wqkv).reshape(B, S, 3, H, Dh), 2, 0, 3, 1, 4)
        q, k, v = qkv[0], qkv[1], qkv[2]
        pq = torch.einsum("bhsd,hdf->bhsf", q, w_phi)
        pk = torch.einsum("bhsd,hdf->bhsf", k, w_phi)
        phi_q = torch.concatenate([_softmax(pq, axis=-1), _softmax(-pq, axis=-1)], axis=-1)
        phi_k = torch.concatenate([_softmax(pk, axis=-1), _softmax(-pk, axis=-1)], axis=-1)
        kv = torch.einsum("bhsf,bhsd->bhfd", phi_k, v)
        z  = torch.einsum("bhsf->bhf", phi_k)
        num = torch.einsum("bhqf,bhfd->bhqd", phi_q, kv)
        den = torch.einsum("bhqf,bhf->bhq", phi_q, z)[..., None] + 1e-6
        o = num / den
        return (lambda x, *d: x.permute(*d))(o, 0, 2, 1, 3).reshape(B, S, D) @ wo

    x = A_q
    x = x + _A_ref(_layernorm(x, axis=-1), A_k, A_v, A_shift_k, A_ssm_k, A_ssm_D)
    x = x + _B_ref(_layernorm(x, axis=-1), B_wqkv, B_w_phi, B_wo)
    x = x + _A_ref(_layernorm(x, axis=-1), A_k, A_v, A_shift_k, A_ssm_k, A_ssm_D)
    x = x + _B_ref(_layernorm(x, axis=-1), B_wqkv, B_w_phi, B_wo)
    return x
```

```asm
; @launch kernel=interleave_layers__ssm_conv_h3__linear_kernel_hedgehog__prompt_kernel grid=(256,1,1) block=(512,1,1) lds=163840
.amdgcn_target "amdgcn-amd-amdhsa--gfx950"
.text
.globl interleave_layers__ssm_conv_h3__linear_kernel_hedgehog__prompt_kernel
.p2align 8
.type interleave_layers__ssm_conv_h3__linear_kernel_hedgehog__prompt_kernel,@function
interleave_layers__ssm_conv_h3__linear_kernel_hedgehog__prompt_kernel:
    s_cmp_ge_u32 s2, 256
    s_cbranch_scc1 L_interleave_layers__ssm_conv_h3__linear_hedgehog__prompt_end_1
    s_load_dwordx2 s[68:69], s[0:1], 96
    s_load_dwordx4 s[4:7], s[0:1], 8
    s_load_dwordx2 s[8:9], s[0:1], 24
    s_load_dwordx4 s[52:55], s[0:1], 32
    v_lshrrev_b32 v1, 6, v0
    s_nop 0
    v_readfirstlane_b32 s70, v1
    s_mov_b32 s71, 0
    s_waitcnt lgkmcnt(0)
    s_add_u32 s60, s68, 0x2880000
    s_addc_u32 s61, s69, 0
    s_load_dword s73, s[60:61], 0
    s_add_u32 s64, s68, 0x2800000
    s_addc_u32 s65, s69, 0
    s_mov_b32 s66, 0x80000
    s_mov_b32 s67, 0x20000
    v_and_b32 v2, 63, v0
    s_and_b32 s10, s2, 7
    s_lshl_b32 s10, s10, 5
    s_lshr_b32 s11, s2, 3
    s_add_u32 s10, s10, s11
    s_mov_b32 s12, s70
    s_cmp_ge_u32 s12, 4
    s_cbranch_scc1 L_interleave_layers__ssm_conv_h3__linear_hedgehog__prompt_prep_2
    v_mov_b32 v4, 137680
    v_mov_b32 v6, 0
    v_mov_b32 v7, 0
    v_mov_b32 v8, 0
    v_mov_b32 v9, 0
    ds_write_b128 v4, v[6:9]
    s_lshr_b32 s56, s2, 4
    s_and_b32 s57, s2, 15
    s_lshl_b32 s14, s56, 7
    s_and_b32 s15, s12, 1
    s_lshl_b32 s15, s15, 6
    s_add_u32 s14, s14, s15
    s_lshl_b32 s15, s57, 6
    s_lshr_b32 s16, s12, 1
    s_lshl_b32 s16, s16, 5
    s_add_u32 s15, s15, s16
    v_and_b32 v1, 7, v2
    v_lshrrev_b32 v3, 3, v2
    v_lshl_add_u32 v4, v3, 2, s15
    v_lshl_add_u32 v3, v1, 3, s14
    v_lshlrev_b32 v5, 11, v3
    v_lshl_add_u32 v5, v4, 1, v5
    v_subrev_u32 v6, 6144, v5
    v_subrev_u32 v7, 2048, v5
    v_lshlrev_b32 v8, 3, v4
    v_lshlrev_b32 v9, 12, v4
    v_lshlrev_b32 v10, 1, v3
    v_sub_u32 v9, v9, v10
    v_add_u32 v9, 4080, v9
    s_mov_b32 s36, 4096
    s_mov_b32 s37, 8192
    s_mov_b32 s38, 12288
    s_mov_b32 s28, s68
    s_mov_b32 s29, s69
    s_mov_b32 s30, 0x400000
    s_mov_b32 s31, 0x20000
    s_mov_b32 s16, s4
    s_mov_b32 s17, s5
    s_mov_b32 s18, 0x400000
    s_mov_b32 s19, 0x20000
    s_mov_b32 s20, s6
    s_mov_b32 s21, s7
    s_mov_b32 s22, 0x400000
    s_mov_b32 s23, 0x20000
    s_mov_b32 s24, s8
    s_mov_b32 s25, s9
    s_mov_b32 s26, 0x2000
    s_mov_b32 s27, 0x20000
    buffer_load_dwordx4 v[52:55], v8, s[24:27], 0 offen
    buffer_load_dwordx4 v[56:59], v8, s[24:27], 0 offen offset:16
    buffer_load_dwordx2 v[12:13], v6, s[16:19], 0 offen
    buffer_load_dwordx2 v[14:15], v6, s[16:19], 0 offen offset:2048
    buffer_load_dwordx2 v[16:17], v7, s[16:19], 0 offen
    buffer_load_dwordx2 v[18:19], v5, s[16:19], 0 offen offset:0
    buffer_load_dwordx2 v[20:21], v5, s[16:19], 0 offen offset:2048
    buffer_load_dwordx2 v[22:23], v5, s[16:19], s36 offen offset:0
    buffer_load_dwordx2 v[24:25], v5, s[16:19], s36 offen offset:2048
    buffer_load_dwordx2 v[26:27], v5, s[16:19], s37 offen offset:0
    buffer_load_dwordx2 v[28:29], v5, s[16:19], s37 offen offset:2048
    buffer_load_dwordx2 v[30:31], v5, s[16:19], s38 offen offset:0
    buffer_load_dwordx2 v[32:33], v5, s[16:19], s38 offen offset:2048
    buffer_load_dwordx2 v[34:35], v5, s[20:23], 0 offen offset:0
    buffer_load_dwordx2 v[36:37], v5, s[20:23], 0 offen offset:2048
    buffer_load_dwordx2 v[38:39], v5, s[20:23], s36 offen offset:0
    buffer_load_dwordx2 v[40:41], v5, s[20:23], s36 offen offset:2048
    buffer_load_dwordx2 v[42:43], v5, s[20:23], s37 offen offset:0
    buffer_load_dwordx2 v[44:45], v5, s[20:23], s37 offen offset:2048
    buffer_load_dwordx2 v[46:47], v5, s[20:23], s38 offen offset:0
    buffer_load_dwordx2 v[48:49], v5, s[20:23], s38 offen offset:2048
    s_lshl_b32 s13, s10, 2
    s_add_u32 s13, s13, s12
    s_lshl_b32 s14, s13, 12
    s_mov_b32 s16, s52
    s_mov_b32 s17, s53
    s_mov_b32 s18, 0x400000
    s_mov_b32 s19, 0x20000
    s_lshl_b32 s59, s13, 1
    s_and_b32 s59, s59, 0xfffffffc
    s_add_u32 s54, s54, s59
    s_addc_u32 s55, s55, 0
    s_load_dword s58, s[54:55], 0
    v_lshlrev_b32 v11, 4, v2
    buffer_load_dwordx4 v[176:179], v11, s[16:19], s14 offen offset:0
    buffer_load_dwordx4 v[180:183], v11, s[16:19], s14 offen offset:1024
    buffer_load_dwordx4 v[184:187], v11, s[16:19], s14 offen offset:2048
    buffer_load_dwordx4 v[188:191], v11, s[16:19], s14 offen offset:3072
    s_mov_b32 s40, 0xffff0000
    s_waitcnt vmcnt(23)
    v_lshlrev_b32 v60, 16, v52
    v_and_b32 v64, s40, v52
    v_lshlrev_b32 v68, 16, v53
    v_and_b32 v72, s40, v53
    v_lshlrev_b32 v61, 16, v54
    v_and_b32 v65, s40, v54
    v_lshlrev_b32 v69, 16, v55
    v_and_b32 v73, s40, v55
    v_lshlrev_b32 v62, 16, v56
    v_and_b32 v66, s40, v56
    v_lshlrev_b32 v70, 16, v57
    v_and_b32 v74, s40, v57
    v_lshlrev_b32 v63, 16, v58
    v_and_b32 v67, s40, v58
    v_lshlrev_b32 v71, 16, v59
    v_and_b32 v75, s40, v59
    s_waitcnt vmcnt(12)
    v_lshlrev_b32 v76, 16, v12
    v_and_b32 v77, s40, v12
    v_lshlrev_b32 v78, 16, v13
    v_and_b32 v79, s40, v13
    v_lshlrev_b32 v80, 16, v14
    v_and_b32 v81, s40, v14
    v_lshlrev_b32 v82, 16, v15
    v_and_b32 v83, s40, v15
    v_lshlrev_b32 v84, 16, v16
    v_and_b32 v85, s40, v16
    v_lshlrev_b32 v86, 16, v17
    v_and_b32 v87, s40, v17
    v_lshlrev_b32 v88, 16, v18
    v_and_b32 v89, s40, v18
    v_lshlrev_b32 v90, 16, v19
    v_and_b32 v91, s40, v19
    v_lshlrev_b32 v92, 16, v20
    v_and_b32 v93, s40, v20
    v_lshlrev_b32 v94, 16, v21
    v_and_b32 v95, s40, v21
    v_lshlrev_b32 v96, 16, v22
    v_and_b32 v97, s40, v22
    v_lshlrev_b32 v98, 16, v23
    v_and_b32 v99, s40, v23
    v_lshlrev_b32 v100, 16, v24
    v_and_b32 v101, s40, v24
    v_lshlrev_b32 v102, 16, v25
    v_and_b32 v103, s40, v25
    v_lshlrev_b32 v104, 16, v26
    v_and_b32 v105, s40, v26
    v_lshlrev_b32 v106, 16, v27
    v_and_b32 v107, s40, v27
    v_lshlrev_b32 v108, 16, v28
    v_and_b32 v109, s40, v28
    v_lshlrev_b32 v110, 16, v29
    v_and_b32 v111, s40, v29
    v_lshlrev_b32 v112, 16, v30
    v_and_b32 v113, s40, v30
    v_lshlrev_b32 v114, 16, v31
    v_and_b32 v115, s40, v31
    v_lshlrev_b32 v116, 16, v32
    v_and_b32 v117, s40, v32
    v_lshlrev_b32 v118, 16, v33
    v_and_b32 v119, s40, v33
    v_pk_mul_f32 v[120:121], v[60:61], v[88:89]
    v_pk_mul_f32 v[122:123], v[62:63], v[90:91]
    v_pk_fma_f32 v[120:121], v[64:65], v[84:85], v[120:121]
    v_pk_fma_f32 v[122:123], v[66:67], v[86:87], v[122:123]
    v_pk_fma_f32 v[120:121], v[68:69], v[80:81], v[120:121]
    v_pk_fma_f32 v[122:123], v[70:71], v[82:83], v[122:123]
    v_pk_fma_f32 v[120:121], v[72:73], v[76:77], v[120:121]
    v_pk_fma_f32 v[122:123], v[74:75], v[78:79], v[122:123]
    v_pk_mul_f32 v[124:125], v[60:61], v[92:93]
    v_pk_mul_f32 v[126:127], v[62:63], v[94:95]
    v_pk_fma_f32 v[124:125], v[64:65], v[88:89], v[124:125]
    v_pk_fma_f32 v[126:127], v[66:67], v[90:91], v[126:127]
    v_pk_fma_f32 v[124:125], v[68:69], v[84:85], v[124:125]
    v_pk_fma_f32 v[126:127], v[70:71], v[86:87], v[126:127]
    v_pk_fma_f32 v[124:125], v[72:73], v[80:81], v[124:125]
    v_pk_fma_f32 v[126:127], v[74:75], v[82:83], v[126:127]
    v_pk_mul_f32 v[128:129], v[60:61], v[96:97]
    v_pk_mul_f32 v[130:131], v[62:63], v[98:99]
    v_pk_fma_f32 v[128:129], v[64:65], v[92:93], v[128:129]
    v_pk_fma_f32 v[130:131], v[66:67], v[94:95], v[130:131]
    v_pk_fma_f32 v[128:129], v[68:69], v[88:89], v[128:129]
    v_pk_fma_f32 v[130:131], v[70:71], v[90:91], v[130:131]
    v_pk_fma_f32 v[128:129], v[72:73], v[84:85], v[128:129]
    v_pk_fma_f32 v[130:131], v[74:75], v[86:87], v[130:131]
    v_pk_mul_f32 v[132:133], v[60:61], v[100:101]
    v_pk_mul_f32 v[134:135], v[62:63], v[102:103]
    v_pk_fma_f32 v[132:133], v[64:65], v[96:97], v[132:133]
    v_pk_fma_f32 v[134:135], v[66:67], v[98:99], v[134:135]
    v_pk_fma_f32 v[132:133], v[68:69], v[92:93], v[132:133]
    v_pk_fma_f32 v[134:135], v[70:71], v[94:95], v[134:135]
    v_pk_fma_f32 v[132:133], v[72:73], v[88:89], v[132:133]
    v_pk_fma_f32 v[134:135], v[74:75], v[90:91], v[134:135]
    v_pk_mul_f32 v[136:137], v[60:61], v[104:105]
    v_pk_mul_f32 v[138:139], v[62:63], v[106:107]
    v_pk_fma_f32 v[136:137], v[64:65], v[100:101], v[136:137]
    v_pk_fma_f32 v[138:139], v[66:67], v[102:103], v[138:139]
    v_pk_fma_f32 v[136:137], v[68:69], v[96:97], v[136:137]
    v_pk_fma_f32 v[138:139], v[70:71], v[98:99], v[138:139]
    v_pk_fma_f32 v[136:137], v[72:73], v[92:93], v[136:137]
    v_pk_fma_f32 v[138:139], v[74:75], v[94:95], v[138:139]
    v_pk_mul_f32 v[140:141], v[60:61], v[108:109]
    v_pk_mul_f32 v[142:143], v[62:63], v[110:111]
    v_pk_fma_f32 v[140:141], v[64:65], v[104:105], v[140:141]
    v_pk_fma_f32 v[142:143], v[66:67], v[106:107], v[142:143]
    v_pk_fma_f32 v[140:141], v[68:69], v[100:101], v[140:141]
    v_pk_fma_f32 v[142:143], v[70:71], v[102:103], v[142:143]
    v_pk_fma_f32 v[140:141], v[72:73], v[96:97], v[140:141]
    v_pk_fma_f32 v[142:143], v[74:75], v[98:99], v[142:143]
    v_pk_mul_f32 v[144:145], v[60:61], v[112:113]
    v_pk_mul_f32 v[146:147], v[62:63], v[114:115]
    v_pk_fma_f32 v[144:145], v[64:65], v[108:109], v[144:145]
    v_pk_fma_f32 v[146:147], v[66:67], v[110:111], v[146:147]
    v_pk_fma_f32 v[144:145], v[68:69], v[104:105], v[144:145]
    v_pk_fma_f32 v[146:147], v[70:71], v[106:107], v[146:147]
    v_pk_fma_f32 v[144:145], v[72:73], v[100:101], v[144:145]
    v_pk_fma_f32 v[146:147], v[74:75], v[102:103], v[146:147]
    v_pk_mul_f32 v[148:149], v[60:61], v[116:117]
    v_pk_mul_f32 v[150:151], v[62:63], v[118:119]
    v_pk_fma_f32 v[148:149], v[64:65], v[112:113], v[148:149]
    v_pk_fma_f32 v[150:151], v[66:67], v[114:115], v[150:151]
    v_pk_fma_f32 v[148:149], v[68:69], v[108:109], v[148:149]
    v_pk_fma_f32 v[150:151], v[70:71], v[110:111], v[150:151]
    v_pk_fma_f32 v[148:149], v[72:73], v[104:105], v[148:149]
    v_pk_fma_f32 v[150:151], v[74:75], v[106:107], v[150:151]
    s_waitcnt vmcnt(4)
    v_lshlrev_b32 v152, 16, v34
    v_and_b32 v153, s40, v34
    v_lshlrev_b32 v154, 16, v35
    v_and_b32 v155, s40, v35
    v_pk_mul_f32 v[120:121], v[120:121], v[152:153]
    v_pk_mul_f32 v[122:123], v[122:123], v[154:155]
    v_lshlrev_b32 v152, 16, v36
    v_and_b32 v153, s40, v36
    v_lshlrev_b32 v154, 16, v37
    v_and_b32 v155, s40, v37
    v_pk_mul_f32 v[124:125], v[124:125], v[152:153]
    v_pk_mul_f32 v[126:127], v[126:127], v[154:155]
    v_lshlrev_b32 v152, 16, v38
    v_and_b32 v153, s40, v38
    v_lshlrev_b32 v154, 16, v39
    v_and_b32 v155, s40, v39
    v_pk_mul_f32 v[128:129], v[128:129], v[152:153]
    v_pk_mul_f32 v[130:131], v[130:131], v[154:155]
    v_lshlrev_b32 v152, 16, v40
    v_and_b32 v153, s40, v40
    v_lshlrev_b32 v154, 16, v41
    v_and_b32 v155, s40, v41
    v_pk_mul_f32 v[132:133], v[132:133], v[152:153]
    v_pk_mul_f32 v[134:135], v[134:135], v[154:155]
    v_lshlrev_b32 v152, 16, v42
    v_and_b32 v153, s40, v42
    v_lshlrev_b32 v154, 16, v43
    v_and_b32 v155, s40, v43
    v_pk_mul_f32 v[136:137], v[136:137], v[152:153]
    v_pk_mul_f32 v[138:139], v[138:139], v[154:155]
    v_lshlrev_b32 v152, 16, v44
    v_and_b32 v153, s40, v44
    v_lshlrev_b32 v154, 16, v45
    v_and_b32 v155, s40, v45
    v_pk_mul_f32 v[140:141], v[140:141], v[152:153]
    v_pk_mul_f32 v[142:143], v[142:143], v[154:155]
    v_lshlrev_b32 v152, 16, v46
    v_and_b32 v153, s40, v46
    v_lshlrev_b32 v154, 16, v47
    v_and_b32 v155, s40, v47
    v_pk_mul_f32 v[144:145], v[144:145], v[152:153]
    v_pk_mul_f32 v[146:147], v[146:147], v[154:155]
    v_lshlrev_b32 v152, 16, v48
    v_and_b32 v153, s40, v48
    v_lshlrev_b32 v154, 16, v49
    v_and_b32 v155, s40, v49
    v_pk_mul_f32 v[148:149], v[148:149], v[152:153]
    v_pk_mul_f32 v[150:151], v[150:151], v[154:155]
    v_cvt_pk_bf16_f32 v156, v148, v144
    v_cvt_pk_bf16_f32 v157, v140, v136
    v_cvt_pk_bf16_f32 v158, v132, v128
    v_cvt_pk_bf16_f32 v159, v124, v120
    buffer_store_dwordx4 v[156:159], v9, s[28:31], 0 offen sc1
    v_cvt_pk_bf16_f32 v160, v149, v145
    v_cvt_pk_bf16_f32 v161, v141, v137
    v_cvt_pk_bf16_f32 v162, v133, v129
    v_cvt_pk_bf16_f32 v163, v125, v121
    buffer_store_dwordx4 v[160:163], v9, s[28:31], s36 offen sc1
    v_cvt_pk_bf16_f32 v164, v150, v146
    v_cvt_pk_bf16_f32 v165, v142, v138
    v_cvt_pk_bf16_f32 v166, v134, v130
    v_cvt_pk_bf16_f32 v167, v126, v122
    buffer_store_dwordx4 v[164:167], v9, s[28:31], s37 offen sc1
    v_cvt_pk_bf16_f32 v168, v151, v147
    v_cvt_pk_bf16_f32 v169, v143, v139
    v_cvt_pk_bf16_f32 v170, v135, v131
    v_cvt_pk_bf16_f32 v171, v127, v123
    buffer_store_dwordx4 v[168:171], v9, s[28:31], s38 offen sc1
    s_waitcnt lgkmcnt(0)
    s_mul_i32 s73, s73, 0x9e3779b1
    s_add_u32 s73, s73, 0x7f4a7c15
    s_waitcnt vmcnt(0)
    s_lshl_b32 s36, s57, 1
    s_lshr_b32 s37, s12, 1
    s_add_u32 s36, s36, s37
    s_lshl_b32 s36, s36, 5
    s_lshl_b32 s37, s56, 1
    s_add_u32 s36, s36, s37
    s_and_b32 s37, s12, 1
    s_add_u32 s36, s36, s37
    s_lshl_b32 s36, s36, 7
    s_add_u32 s36, s36, 262144
    v_mov_b32 v253, 0
    v_mov_b32 v254, s73
    s_mov_b64 exec, 1
    buffer_store_dword v254, v253, s[64:67], s36 offen sc1
    s_mov_b64 exec, -1
L_interleave_layers__ssm_conv_h3__linear_hedgehog__prompt_sf_5:
    s_mul_i32 s15, s12, 16640
    s_mul_i32 s28, s12, 4608
    s_add_u32 s28, s28, 66560
    v_lshlrev_b32 v3, 4, v2
    v_mov_b32 v8, 0
    v_mov_b32 v9, 0
    v_mov_b32 v10, 0
    v_mov_b32 v11, 0
    v_and_b32 v4, 31, v2
    v_lshlrev_b32 v4, 4, v4
    v_add_u32 v4, s28, v4
    ds_write_b128 v4, v[8:11] offset:4096
    v_add_u32 v5, s15, v3
    s_and_b32 s31, s13, 1
    s_lshl_b32 s31, s31, 4
    s_lshr_b32 s29, s58, s31
    s_lshl_b32 s29, s29, 16
    s_mov_b32 s32, 0xffff0000
    v_cmp_eq_u32 s[34:35], 0, v2
    s_waitcnt vmcnt(1)
    v_lshlrev_b32 v6, 16, v176
    v_add_f32 v6, s29, v6
    v_cvt_pk_bf16_f32 v6, v6, v6
    v_and_b32 v6, 0xffff, v6
    v_and_or_b32 v6, v176, s32, v6
    v_cndmask_b32 v176, v176, v6, s[34:35]
    v_readlane_b32 s36, v180, 0
    s_nop 1
    v_mov_b32 v71, s36
    v_mov_b32_dpp v71, v176 wave_shl:1 row_mask:0xf bank_mask:0xf
    v_readlane_b32 s36, v181, 0
    s_nop 1
    v_mov_b32 v76, s36
    v_mov_b32_dpp v76, v177 wave_shl:1 row_mask:0xf bank_mask:0xf
    v_alignbit_b32 v64, v177, v176, 16
    v_mov_b32 v68, v177
    v_alignbit_b32 v65, v178, v177, 16
    v_mov_b32 v69, v178
    v_alignbit_b32 v66, v179, v178, 16
    v_mov_b32 v70, v179
    v_alignbit_b32 v67, v71, v179, 16
    v_alignbit_b32 v75, v76, v71, 16
    v_mov_b32 v72, v65
    v_mov_b32 v73, v66
    v_mov_b32 v74, v67
    ds_write_b128 v5, v[176:179] offset:32
    ds_write_b128 v5, v[64:67] offset:4192
    ds_write_b128 v5, v[68:71] offset:8352
    ds_write_b128 v5, v[72:75] offset:12512
    v_mov_b32 v100, 0
    v_mov_b32 v101, 0
    v_mov_b32 v102, 0
    v_lshlrev_b32 v103, 16, v176
    v_mov_b32 v104, 0
    v_mov_b32 v105, 0
    v_mov_b32 v106, 0
    v_mov_b32 v107, v176
    v_mov_b32 v108, 0
    v_mov_b32 v109, 0
    v_mov_b32 v110, v103
    v_mov_b32 v111, v64
    v_mov_b32 v7, s15
    s_mov_b64 exec, 1
    ds_write_b128 v7, v[8:11] offset:0
    ds_write_b128 v7, v[8:11] offset:4160
    ds_write_b128 v7, v[8:11] offset:8320
    ds_write_b128 v7, v[8:11] offset:12480
    ds_write_b128 v7, v[8:11] offset:16
    ds_write_b128 v7, v[100:103] offset:4176
    ds_write_b128 v7, v[104:107] offset:8336
    ds_write_b128 v7, v[108:111] offset:12496
    s_mov_b64 exec, -1
    v_readlane_b32 s36, v184, 0
    s_nop 1
    v_mov_b32 v87, s36
    v_mov_b32_dpp v87, v180 wave_shl:1 row_mask:0xf bank_mask:0xf
    v_readlane_b32 s36, v185, 0
    s_nop 1
    v_mov_b32 v92, s36
    v_mov_b32_dpp v92, v181 wave_shl:1 row_mask:0xf bank_mask:0xf
    v_alignbit_b32 v80, v181, v180, 16
    v_mov_b32 v84, v181
    v_alignbit_b32 v81, v182, v181, 16
    v_mov_b32 v85, v182
    v_alignbit_b32 v82, v183, v182, 16
    v_mov_b32 v86, v183
    v_alignbit_b32 v83, v87, v183, 16
    v_alignbit_b32 v91, v92, v87, 16
    v_mov_b32 v88, v81
    v_mov_b32 v89, v82
    v_mov_b32 v90, v83
    ds_write_b128 v5, v[180:183] offset:1056
    ds_write_b128 v5, v[80:83] offset:5216
    ds_write_b128 v5, v[84:87] offset:9376
    ds_write_b128 v5, v[88:91] offset:13536
    v_readlane_b32 s36, v188, 0
    s_nop 1
    v_mov_b32 v71, s36
    v_mov_b32_dpp v71, v184 wave_shl:1 row_mask:0xf bank_mask:0xf
    v_readlane_b32 s36, v189, 0
    s_nop 1
    v_mov_b32 v76, s36
    v_mov_b32_dpp v76, v185 wave_shl:1 row_mask:0xf bank_mask:0xf
    v_alignbit_b32 v64, v185, v184, 16
    v_mov_b32 v68, v185
    v_alignbit_b32 v65, v186, v185, 16
    v_mov_b32 v69, v186
    v_alignbit_b32 v66, v187, v186, 16
    v_mov_b32 v70, v187
    v_alignbit_b32 v67, v71, v187, 16
    v_alignbit_b32 v75, v76, v71, 16
    v_mov_b32 v72, v65
    v_mov_b32 v73, v66
    v_mov_b32 v74, v67
    ds_write_b128 v5, v[184:187] offset:2080
    ds_write_b128 v5, v[64:67] offset:6240
    ds_write_b128 v5, v[68:71] offset:10400
    ds_write_b128 v5, v[72:75] offset:14560
    v_mov_b32_dpp v87, v188 wave_shl:1 row_mask:0xf bank_mask:0xf
    v_mov_b32_dpp v92, v189 wave_shl:1 row_mask:0xf bank_mask:0xf
    v_alignbit_b32 v80, v189, v188, 16
    v_mov_b32 v84, v189
    v_alignbit_b32 v81, v190, v189, 16
    v_mov_b32 v85, v190
    v_alignbit_b32 v82, v191, v190, 16
    v_mov_b32 v86, v191
    v_alignbit_b32 v83, v87, v191, 16
    v_alignbit_b32 v91, v92, v87, 16
    v_mov_b32 v88, v81
    v_mov_b32 v89, v82
    v_mov_b32 v90, v83
    ds_write_b128 v5, v[188:191] offset:3104
    ds_write_b128 v5, v[80:83] offset:7264
    ds_write_b128 v5, v[84:87] offset:11424
    ds_write_b128 v5, v[88:91] offset:15584
    s_lshr_b32 s36, s13, 5
    s_lshl_b32 s36, s36, 12
    s_add_u32 s36, s36, 262144
    v_and_b32 v253, 63, v0
    v_lshlrev_b32 v253, 7, v253
    s_mov_b32 exec_lo, 0xffffffff
    s_mov_b32 exec_hi, 0
    s_mov_b32 s62, 0
L_interleave_layers__ssm_conv_h3__linear_hedgehog__prompt_pl_7:
    buffer_load_dword v248, v253, s[64:67], s36 offen sc1
    s_waitcnt vmcnt(0)
    v_cmp_eq_u32 vcc, s73, v248
    s_nop 3
    s_cmp_eq_u64 vcc, exec
    s_cbranch_scc1 L_interleave_layers__ssm_conv_h3__linear_hedgehog__prompt_pd_8
    s_sleep 1
    s_add_u32 s62, s62, 1
    s_cmp_lt_u32 s62, 0x10000
    s_cbranch_scc1 L_interleave_layers__ssm_conv_h3__linear_hedgehog__prompt_pl_7
L_interleave_layers__ssm_conv_h3__linear_hedgehog__prompt_pd_8:
    s_mov_b64 exec, -1
L_interleave_layers__ssm_conv_h3__linear_hedgehog__prompt_np_6:
    s_mov_b32 s20, s68
    s_mov_b32 s21, s69
    s_mov_b32 s22, 0x400000
    s_mov_b32 s23, 0x20000
    s_add_u32 s24, s68, 0x400000
    s_addc_u32 s25, s69, 0
    s_mov_b32 s26, 0x400000
    s_mov_b32 s27, 0x20000
    s_mov_b32 m0, s28
    s_nop 0
    buffer_load_dwordx4 v3, s[20:23], s14 offen offset:0 sc1 lds
    buffer_load_dwordx4 v3, s[20:23], s14 offen offset:1024 sc1 lds
    buffer_load_dwordx4 v3, s[20:23], s14 offen offset:2048 sc1 lds
    buffer_load_dwordx4 v3, s[20:23], s14 offen offset:3072 sc1 lds
    s_mov_b32 s59, s28
    s_load_dwordx2 s[46:47], s[0:1], 0
    s_and_b32 s36, s2, 7
    s_lshr_b32 s37, s2, 3
    s_and_b32 s38, s36, 3
    s_lshl_b32 s38, s38, 2
    s_and_b32 s39, s37, 3
    s_add_u32 s38, s38, s39
    s_lshr_b32 s39, s36, 2
    s_lshl_b32 s39, s39, 3
    s_lshr_b32 s41, s37, 2
    s_add_u32 s39, s39, s41
    v_and_b32 v2, 63, v0
    v_lshrrev_b32 v3, 4, v2
    v_lshlrev_b32 v3, 2, v3
    v_and_b32 v7, 3, v2
    v_add_u32 v3, v3, v7
    s_lshl_b32 s41, s70, 4
    v_add_u32 v3, s41, v3
    v_bfe_u32 v7, v2, 2, 2
    v_mul_u32_u24 v6, 272, v3
    v_lshl_add_u32 v6, v7, 6, v6
    v_lshlrev_b32 v5, 3, v3
    s_lshl_b32 s41, s38, 7
    v_add_u32 v3, s41, v3
    v_lshlrev_b32 v4, 11, v3
    v_lshl_add_u32 v4, v7, 5, v4
    s_lshl_b32 s41, s39, 7
    v_add_u32 v4, s41, v4
    s_waitcnt lgkmcnt(0)
    s_mov_b32 s48, s46
    s_mov_b32 s49, s47
    s_mov_b32 s50, 0x400000
    s_mov_b32 s51, 0x20000
    buffer_load_dwordx4 v[232:235], v4, s[48:51], 0 offen
    buffer_load_dwordx4 v[236:239], v4, s[48:51], 0 offen offset:16
    s_mov_b32 s28, s59
    v_and_b32 v8, 15, v2
    v_lshrrev_b32 v9, 4, v2
    v_add_u32 v10, 1, v8
    v_and_b32 v11, 3, v10
    v_sub_u32 v10, v10, v11
    v_lshlrev_b32 v10, 1, v10
    v_mul_u32_u24 v11, 4160, v11
    v_add_u32 v10, v10, v11
    v_lshl_add_u32 v10, v9, 4, v10
    v_add_u32 v12, s15, v10
    v_lshlrev_b32 v10, 5, v8
    v_lshlrev_b32 v11, 4, v9
    v_sub_u32 v11, v11, v10
    s_add_u32 s33, s28, 480
    v_add_u32 v13, s33, v11
    s_waitcnt vmcnt(2) lgkmcnt(0)
    s_barrier
    v_mov_b32 v16, 0
    v_mov_b32 v17, 0
    v_mov_b32 v18, 0
    v_mov_b32 v19, 0
    v_mov_b32 v20, 0
    v_mov_b32 v21, 0
    v_mov_b32 v22, 0
    v_mov_b32 v23, 0
    v_mov_b32 v24, 0
    v_mov_b32 v25, 0
    v_mov_b32 v26, 0
    v_mov_b32 v27, 0
    v_mov_b32 v28, 0
    v_mov_b32 v29, 0
    v_mov_b32 v30, 0
    v_mov_b32 v31, 0
    v_mov_b32 v32, 0
    v_mov_b32 v33, 0
    v_mov_b32 v34, 0
    v_mov_b32 v35, 0
    v_mov_b32 v36, 0
    v_mov_b32 v37, 0
    v_mov_b32 v38, 0
    v_mov_b32 v39, 0
    v_mov_b32 v40, 0
    v_mov_b32 v41, 0
    v_mov_b32 v42, 0
    v_mov_b32 v43, 0
    v_mov_b32 v44, 0
    v_mov_b32 v45, 0
    v_mov_b32 v46, 0
    v_mov_b32 v47, 0
    ds_read_b128 v[80:83], v13 offset:3584
    ds_read_b64 v[48:49], v12 offset:0
    ds_read_b64 v[50:51], v12 offset:8
    ds_read_b128 v[84:87], v13 offset:3072
    ds_read_b64 v[52:53], v12 offset:512
    ds_read_b64 v[54:55], v12 offset:520
    ds_read_b128 v[88:91], v13 offset:2560
    ds_read_b64 v[56:57], v12 offset:1024
    ds_read_b64 v[58:59], v12 offset:1032
    ds_read_b128 v[92:95], v13 offset:2048
    ds_read_b64 v[60:61], v12 offset:1536
    ds_read_b64 v[62:63], v12 offset:1544
    ds_read_b128 v[96:99], v13 offset:1536
    ds_read_b64 v[64:65], v12 offset:2048
    ds_read_b64 v[66:67], v12 offset:2056
    ds_read_b128 v[100:103], v13 offset:1024
    ds_read_b64 v[68:69], v12 offset:2560
    ds_read_b64 v[70:71], v12 offset:2568
    ds_read_b128 v[104:107], v13 offset:512
    ds_read_b64 v[72:73], v12 offset:3072
    ds_read_b64 v[74:75], v12 offset:3080
    ds_read_b128 v[108:111], v13 offset:0
    ds_read_b64 v[76:77], v12 offset:3584
    ds_read_b64 v[78:79], v12 offset:3592
    v_add_u32 v12, 64, v12
    v_add_u32 v13, 64, v13
    s_mov_b32 s36, 0
L_interleave_layers__ssm_conv_h3__linear_hedgehog__prompt_loop_9:
    s_waitcnt lgkmcnt(0)
    v_mfma_f32_16x16x32_bf16 v[16:19], v[48:51], v[80:83], v[16:19]
    ds_read_b128 v[144:147], v13 offset:3584
    v_mfma_f32_16x16x32_bf16 v[20:23], v[48:51], v[84:87], v[20:23]
    ds_read_b64 v[112:113], v12 offset:0
    v_mfma_f32_16x16x32_bf16 v[24:27], v[48:51], v[88:91], v[24:27]
    ds_read_b64 v[114:115], v12 offset:8
    v_mfma_f32_16x16x32_bf16 v[28:31], v[48:51], v[92:95], v[28:31]
    ds_read_b128 v[148:151], v13 offset:3072
    v_mfma_f32_16x16x32_bf16 v[32:35], v[48:51], v[96:99], v[32:35]
    ds_read_b64 v[116:117], v12 offset:512
    v_mfma_f32_16x16x32_bf16 v[36:39], v[48:51], v[100:103], v[36:39]
    ds_read_b64 v[118:119], v12 offset:520
    v_mfma_f32_16x16x32_bf16 v[40:43], v[48:51], v[104:107], v[40:43]
    ds_read_b128 v[152:155], v13 offset:2560
    v_mfma_f32_16x16x32_bf16 v[44:47], v[48:51], v[108:111], v[44:47]
    ds_read_b64 v[120:121], v12 offset:1024
    v_mfma_f32_16x16x32_bf16 v[20:23], v[52:55], v[80:83], v[20:23]
    ds_read_b64 v[122:123], v12 offset:1032
    v_mfma_f32_16x16x32_bf16 v[24:27], v[52:55], v[84:87], v[24:27]
    ds_read_b128 v[156:159], v13 offset:2048
    v_mfma_f32_16x16x32_bf16 v[28:31], v[52:55], v[88:91], v[28:31]
    ds_read_b64 v[124:125], v12 offset:1536
    v_mfma_f32_16x16x32_bf16 v[32:35], v[52:55], v[92:95], v[32:35]
    ds_read_b64 v[126:127], v12 offset:1544
    v_mfma_f32_16x16x32_bf16 v[36:39], v[52:55], v[96:99], v[36:39]
    ds_read_b128 v[160:163], v13 offset:1536
    v_mfma_f32_16x16x32_bf16 v[40:43], v[52:55], v[100:103], v[40:43]
    ds_read_b64 v[128:129], v12 offset:2048
    v_mfma_f32_16x16x32_bf16 v[44:47], v[52:55], v[104:107], v[44:47]
    ds_read_b64 v[130:131], v12 offset:2056
    v_mfma_f32_16x16x32_bf16 v[24:27], v[56:59], v[80:83], v[24:27]
    ds_read_b128 v[164:167], v13 offset:1024
    v_mfma_f32_16x16x32_bf16 v[28:31], v[56:59], v[84:87], v[28:31]
    ds_read_b64 v[132:133], v12 offset:2560
    v_mfma_f32_16x16x32_bf16 v[32:35], v[56:59], v[88:91], v[32:35]
    ds_read_b64 v[134:135], v12 offset:2568
    v_mfma_f32_16x16x32_bf16 v[36:39], v[56:59], v[92:95], v[36:39]
    ds_read_b128 v[168:171], v13 offset:512
    v_mfma_f32_16x16x32_bf16 v[40:43], v[56:59], v[96:99], v[40:43]
    ds_read_b64 v[136:137], v12 offset:3072
    v_mfma_f32_16x16x32_bf16 v[44:47], v[56:59], v[100:103], v[44:47]
    ds_read_b64 v[138:139], v12 offset:3080
    v_mfma_f32_16x16x32_bf16 v[28:31], v[60:63], v[80:83], v[28:31]
    ds_read_b128 v[172:175], v13 offset:0
    v_mfma_f32_16x16x32_bf16 v[32:35], v[60:63], v[84:87], v[32:35]
    ds_read_b64 v[140:141], v12 offset:3584
    v_mfma_f32_16x16x32_bf16 v[36:39], v[60:63], v[88:91], v[36:39]
    ds_read_b64 v[142:143], v12 offset:3592
    v_mfma_f32_16x16x32_bf16 v[40:43], v[60:63], v[92:95], v[40:43]
    v_mfma_f32_16x16x32_bf16 v[44:47], v[60:63], v[96:99], v[44:47]
    v_mfma_f32_16x16x32_bf16 v[32:35], v[64:67], v[80:83], v[32:35]
    v_mfma_f32_16x16x32_bf16 v[36:39], v[64:67], v[84:87], v[36:39]
    v_mfma_f32_16x16x32_bf16 v[40:43], v[64:67], v[88:91], v[40:43]
    v_mfma_f32_16x16x32_bf16 v[44:47], v[64:67], v[92:95], v[44:47]
    v_mfma_f32_16x16x32_bf16 v[36:39], v[68:71], v[80:83], v[36:39]
    v_mfma_f32_16x16x32_bf16 v[40:43], v[68:71], v[84:87], v[40:43]
    v_mfma_f32_16x16x32_bf16 v[44:47], v[68:71], v[88:91], v[44:47]
    v_mfma_f32_16x16x32_bf16 v[40:43], v[72:75], v[80:83], v[40:43]
    v_mfma_f32_16x16x32_bf16 v[44:47], v[72:75], v[84:87], v[44:47]
    v_mfma_f32_16x16x32_bf16 v[44:47], v[76:79], v[80:83], v[44:47]
    v_add_u32 v12, 64, v12
    v_add_u32 v13, 64, v13
    s_waitcnt lgkmcnt(0)
    v_mfma_f32_16x16x32_bf16 v[16:19], v[112:115], v[144:147], v[16:19]
    ds_read_b128 v[80:83], v13 offset:3584
    v_mfma_f32_16x16x32_bf16 v[20:23], v[112:115], v[148:151], v[20:23]
    ds_read_b64 v[48:49], v12 offset:0
    v_mfma_f32_16x16x32_bf16 v[24:27], v[112:115], v[152:155], v[24:27]
    ds_read_b64 v[50:51], v12 offset:8
    v_mfma_f32_16x16x32_bf16 v[28:31], v[112:115], v[156:159], v[28:31]
    ds_read_b128 v[84:87], v13 offset:3072
    v_mfma_f32_16x16x32_bf16 v[32:35], v[112:115], v[160:163], v[32:35]
    ds_read_b64 v[52:53], v12 offset:512
    v_mfma_f32_16x16x32_bf16 v[36:39], v[112:115], v[164:167], v[36:39]
    ds_read_b64 v[54:55], v12 offset:520
    v_mfma_f32_16x16x32_bf16 v[40:43], v[112:115], v[168:171], v[40:43]
    ds_read_b128 v[88:91], v13 offset:2560
    v_mfma_f32_16x16x32_bf16 v[44:47], v[112:115], v[172:175], v[44:47]
    ds_read_b64 v[56:57], v12 offset:1024
    v_mfma_f32_16x16x32_bf16 v[20:23], v[116:119], v[144:147], v[20:23]
    ds_read_b64 v[58:59], v12 offset:1032
    v_mfma_f32_16x16x32_bf16 v[24:27], v[116:119], v[148:151], v[24:27]
    ds_read_b128 v[92:95], v13 offset:2048
    v_mfma_f32_16x16x32_bf16 v[28:31], v[116:119], v[152:155], v[28:31]
    ds_read_b64 v[60:61], v12 offset:1536
    v_mfma_f32_16x16x32_bf16 v[32:35], v[116:119], v[156:159], v[32:35]
    ds_read_b64 v[62:63], v12 offset:1544
    v_mfma_f32_16x16x32_bf16 v[36:39], v[116:119], v[160:163], v[36:39]
    ds_read_b128 v[96:99], v13 offset:1536
    v_mfma_f32_16x16x32_bf16 v[40:43], v[116:119], v[164:167], v[40:43]
    ds_read_b64 v[64:65], v12 offset:2048
    v_mfma_f32_16x16x32_bf16 v[44:47], v[116:119], v[168:171], v[44:47]
    ds_read_b64 v[66:67], v12 offset:2056
    v_mfma_f32_16x16x32_bf16 v[24:27], v[120:123], v[144:147], v[24:27]
    ds_read_b128 v[100:103], v13 offset:1024
    v_mfma_f32_16x16x32_bf16 v[28:31], v[120:123], v[148:151], v[28:31]
    ds_read_b64 v[68:69], v12 offset:2560
    v_mfma_f32_16x16x32_bf16 v[32:35], v[120:123], v[152:155], v[32:35]
    ds_read_b64 v[70:71], v12 offset:2568
    v_mfma_f32_16x16x32_bf16 v[36:39], v[120:123], v[156:159], v[36:39]
    ds_read_b128 v[104:107], v13 offset:512
    v_mfma_f32_16x16x32_bf16 v[40:43], v[120:123], v[160:163], v[40:43]
    ds_read_b64 v[72:73], v12 offset:3072
    v_mfma_f32_16x16x32_bf16 v[44:47], v[120:123], v[164:167], v[44:47]
    ds_read_b64 v[74:75], v12 offset:3080
    v_mfma_f32_16x16x32_bf16 v[28:31], v[124:127], v[144:147], v[28:31]
    ds_read_b128 v[108:111], v13 offset:0
    v_mfma_f32_16x16x32_bf16 v[32:35], v[124:127], v[148:151], v[32:35]
    ds_read_b64 v[76:77], v12 offset:3584
    v_mfma_f32_16x16x32_bf16 v[36:39], v[124:127], v[152:155], v[36:39]
    ds_read_b64 v[78:79], v12 offset:3592
    v_mfma_f32_16x16x32_bf16 v[40:43], v[124:127], v[156:159], v[40:43]
    v_mfma_f32_16x16x32_bf16 v[44:47], v[124:127], v[160:163], v[44:47]
    v_mfma_f32_16x16x32_bf16 v[32:35], v[128:131], v[144:147], v[32:35]
    v_mfma_f32_16x16x32_bf16 v[36:39], v[128:131], v[148:151], v[36:39]
    v_mfma_f32_16x16x32_bf16 v[40:43], v[128:131], v[152:155], v[40:43]
    v_mfma_f32_16x16x32_bf16 v[44:47], v[128:131], v[156:159], v[44:47]
    v_mfma_f32_16x16x32_bf16 v[36:39], v[132:135], v[144:147], v[36:39]
    v_mfma_f32_16x16x32_bf16 v[40:43], v[132:135], v[148:151], v[40:43]
    v_mfma_f32_16x16x32_bf16 v[44:47], v[132:135], v[152:155], v[44:47]
    v_mfma_f32_16x16x32_bf16 v[40:43], v[136:139], v[144:147], v[40:43]
    v_mfma_f32_16x16x32_bf16 v[44:47], v[136:139], v[148:151], v[44:47]
    v_mfma_f32_16x16x32_bf16 v[44:47], v[140:143], v[144:147], v[44:47]
    v_add_u32 v12, 64, v12
    v_add_u32 v13, 64, v13
    s_add_u32 s36, s36, 1
    s_cmp_lt_u32 s36, 4
    s_cbranch_scc1 L_interleave_layers__ssm_conv_h3__linear_hedgehog__prompt_loop_9
    s_waitcnt lgkmcnt(0)
    v_cvt_pk_bf16_f32 v48, v16, v17
    v_cvt_pk_bf16_f32 v49, v18, v19
    v_cvt_pk_bf16_f32 v50, v20, v21
    v_cvt_pk_bf16_f32 v51, v22, v23
    v_cvt_pk_bf16_f32 v52, v24, v25
    v_cvt_pk_bf16_f32 v53, v26, v27
    v_cvt_pk_bf16_f32 v54, v28, v29
    v_cvt_pk_bf16_f32 v55, v30, v31
    v_cvt_pk_bf16_f32 v56, v32, v33
    v_cvt_pk_bf16_f32 v57, v34, v35
    v_cvt_pk_bf16_f32 v58, v36, v37
    v_cvt_pk_bf16_f32 v59, v38, v39
    v_cvt_pk_bf16_f32 v60, v40, v41
    v_cvt_pk_bf16_f32 v61, v42, v43
    v_cvt_pk_bf16_f32 v62, v44, v45
    v_cvt_pk_bf16_f32 v63, v46, v47
    v_mul_u32_u24 v10, 144, v8
    v_lshl_add_u32 v10, v9, 3, v10
    s_lshl_b32 s37, s12, 5
    s_add_u32 s37, s37, 98304
    v_add_u32 v10, s37, v10
    ds_write_b64 v10, v[48:49] offset:0
    ds_write_b64 v10, v[50:51] offset:2304
    ds_write_b64 v10, v[52:53] offset:4608
    ds_write_b64 v10, v[54:55] offset:6912
    ds_write_b64 v10, v[56:57] offset:9216
    ds_write_b64 v10, v[58:59] offset:11520
    ds_write_b64 v10, v[60:61] offset:13824
    ds_write_b64 v10, v[62:63] offset:16128
    v_lshrrev_b32 v11, 3, v0
    v_mul_u32_u24 v11, 144, v11
    v_and_b32 v14, 7, v0
    v_lshl_add_u32 v11, v14, 4, v11
    v_add_u32 v11, 98304, v11
    v_lshrrev_b32 v14, 3, v0
    v_lshlrev_b32 v14, 15, v14
    v_and_b32 v15, 7, v0
    v_lshl_add_u32 v14, v15, 4, v14
    s_lshl_b32 s37, s10, 7
    v_add_u32 v14, s37, v14
    s_waitcnt lgkmcnt(0)
    v_mov_b32 v250, 137680
    v_mov_b32 v251, 1
    s_mov_b64 exec, 1
    ds_add_u32 v250, v251
    s_mov_b64 exec, -1
    v_mov_b32 v250, 137680
    s_mov_b32 s62, 0
L_interleave_layers__ssm_conv_h3__linear_hedgehog__prompt_lw_10:
    ds_read_b32 v251, v250
    s_waitcnt lgkmcnt(0)
    v_readfirstlane_b32 s61, v251
    s_nop 3
    s_cmp_ge_u32 s61, 4
    s_cbranch_scc1 L_interleave_layers__ssm_conv_h3__linear_hedgehog__prompt_lwd_11
    s_add_u32 s62, s62, 1
    s_cmp_lt_u32 s62, 0x100000
    s_cbranch_scc1 L_interleave_layers__ssm_conv_h3__linear_hedgehog__prompt_lw_10
L_interleave_layers__ssm_conv_h3__linear_hedgehog__prompt_lwd_11:
    ds_read_b128 v[80:83], v11 offset:0
    ds_read_b128 v[84:87], v11 offset:4608
    ds_read_b128 v[88:91], v11 offset:9216
    ds_read_b128 v[92:95], v11 offset:13824
    s_mov_b32 s38, 0
    s_waitcnt lgkmcnt(3)
    buffer_store_dwordx4 v[80:83], v14, s[24:27], s38 offen sc1
    s_mov_b32 s38, 1048576
    s_waitcnt lgkmcnt(2)
    buffer_store_dwordx4 v[84:87], v14, s[24:27], s38 offen sc1
    s_mov_b32 s38, 2097152
    s_waitcnt lgkmcnt(1)
    buffer_store_dwordx4 v[88:91], v14, s[24:27], s38 offen sc1
    s_mov_b32 s38, 3145728
    s_waitcnt lgkmcnt(0)
    buffer_store_dwordx4 v[92:95], v14, s[24:27], s38 offen sc1
    s_waitcnt vmcnt(4)
    s_and_b32 s36, s2, 7
    s_lshr_b32 s37, s2, 3
    s_and_b32 s38, s36, 3
    s_lshl_b32 s38, s38, 2
    s_and_b32 s39, s37, 3
    s_add_u32 s38, s38, s39
    s_lshr_b32 s39, s36, 2
    s_lshl_b32 s39, s39, 3
    s_lshr_b32 s41, s37, 2
    s_add_u32 s39, s39, s41
    v_and_b32 v2, 63, v0
    v_lshrrev_b32 v3, 4, v2
    v_lshlrev_b32 v3, 2, v3
    v_and_b32 v7, 3, v2
    v_add_u32 v3, v3, v7
    s_lshl_b32 s41, s70, 4
    v_add_u32 v3, s41, v3
    v_bfe_u32 v7, v2, 2, 2
    v_mul_u32_u24 v6, 272, v3
    v_lshl_add_u32 v6, v7, 6, v6
    v_lshlrev_b32 v5, 3, v3
    s_lshl_b32 s41, s38, 7
    v_add_u32 v3, s41, v3
    v_lshlrev_b32 v4, 11, v3
    v_lshl_add_u32 v4, v7, 5, v4
    s_lshl_b32 s41, s39, 7
    v_add_u32 v4, s41, v4
    s_mov_b32 s40, 0xffff0000
    s_add_u32 s28, s68, 0x2a00000
    s_addc_u32 s29, s69, 0
    s_mov_b32 s30, 0x100000
    s_mov_b32 s31, 0x20000
    v_lshlrev_b32 v16, 16, v232
    v_and_b32 v17, s40, v232
    v_lshlrev_b32 v18, 16, v233
    v_and_b32 v19, s40, v233
    v_lshlrev_b32 v20, 16, v234
    v_and_b32 v21, s40, v234
    v_lshlrev_b32 v22, 16, v235
    v_and_b32 v23, s40, v235
    v_lshlrev_b32 v24, 16, v236
    v_and_b32 v25, s40, v236
    v_lshlrev_b32 v26, 16, v237
    v_and_b32 v27, s40, v237
    v_lshlrev_b32 v28, 16, v238
    v_and_b32 v29, s40, v238
    v_lshlrev_b32 v30, 16, v239
    v_and_b32 v31, s40, v239
    s_mov_b32 s43, 0
    v_pk_add_f32 v[32:33], v[16:17], v[18:19]
    v_pk_mul_f32 v[34:35], v[16:17], v[16:17]
    v_pk_add_f32 v[36:37], v[20:21], v[22:23]
    v_pk_mul_f32 v[38:39], v[18:19], v[18:19]
    v_pk_fma_f32 v[34:35], v[20:21], v[20:21], v[34:35]
    v_pk_fma_f32 v[38:39], v[22:23], v[22:23], v[38:39]
    v_pk_fma_f32 v[34:35], v[24:25], v[24:25], v[34:35]
    v_pk_fma_f32 v[38:39], v[26:27], v[26:27], v[38:39]
    v_pk_add_f32 v[32:33], v[32:33], v[24:25]
    v_pk_add_f32 v[32:33], v[32:33], v[26:27]
    v_pk_fma_f32 v[34:35], v[28:29], v[28:29], v[34:35]
    v_pk_fma_f32 v[38:39], v[30:31], v[30:31], v[38:39]
    v_pk_add_f32 v[36:37], v[36:37], v[28:29]
    v_pk_add_f32 v[36:37], v[36:37], v[30:31]
    v_pk_add_f32 v[32:33], v[32:33], v[36:37]
    v_pk_add_f32 v[34:35], v[34:35], v[38:39]
    v_add_f32 v32, v32, v33
    v_add_f32 v33, v34, v35
    s_nop 0
    v_add_f32_dpp v32, v32, v32 row_ror:4 row_mask:0xf bank_mask:0xf
    v_add_f32_dpp v33, v33, v33 row_ror:4 row_mask:0xf bank_mask:0xf
    s_nop 0
    v_add_f32_dpp v32, v32, v32 row_ror:8 row_mask:0xf bank_mask:0xf
    v_add_f32_dpp v33, v33, v33 row_ror:8 row_mask:0xf bank_mask:0xf
    s_lshl_b32 s42, s38, 4
    s_add_u32 s42, s42, s39
    s_lshl_b32 s42, s42, 10
    s_add_u32 s42, s42, s43
    s_mov_b32 exec_lo, 0x000f000f
    s_mov_b32 exec_hi, 0x000f000f
    buffer_store_dwordx2 v[32:33], v5, s[28:31], s42 offen sc1
    s_mov_b64 exec, -1
    s_branch L_interleave_layers__ssm_conv_h3__linear_hedgehog__prompt_cjoin_3
L_interleave_layers__ssm_conv_h3__linear_hedgehog__prompt_prep_2:
    s_waitcnt lgkmcnt(0)
    s_mul_i32 s73, s73, 0x9e3779b1
    s_add_u32 s73, s73, 0x7f4a7c15
    s_load_dwordx4 s[4:7], s[0:1], 56
    s_load_dwordx2 s[8:9], s[0:1], 72
    s_sub_u32 s12, s12, 4
    s_and_b32 s13, s2, 7
    s_lshr_b32 s14, s2, 3
    s_lshl_b32 s13, s13, 2
    s_add_u32 s13, s13, s12
    v_and_b32 v3, 31, v2
    v_lshrrev_b32 v4, 5, v2
    s_lshl_b32 s15, s14, 5
    v_add_u32 v5, s15, v3
    v_mul_u32_u24 v6, 6144, v5
    v_lshl_add_u32 v6, v4, 4, v6
    s_lshl_b32 s15, s13, 6
    v_add_u32 v6, s15, v6
    v_lshlrev_b32 v7, 11, v5
    v_lshl_add_u32 v7, v4, 4, v7
    v_add_u32 v7, s15, v7
    v_lshlrev_b32 v8, 4, v2
    s_add_u32 s28, s68, 0x2000000
    s_addc_u32 s29, s69, 0
    s_mov_b32 s30, 0x600000
    s_mov_b32 s31, 0x20000
    s_add_u32 s32, s68, 0x2600000
    s_addc_u32 s33, s69, 0
    s_mov_b32 s34, 0x200000
    s_mov_b32 s35, 0x20000
    s_waitcnt lgkmcnt(0)
    s_mov_b32 s16, s4
    s_mov_b32 s17, s5
    s_mov_b32 s18, 0x600000
    s_mov_b32 s19, 0x20000
    s_mov_b32 s20, s6
    s_mov_b32 s21, s7
    s_mov_b32 s22, 0x10000
    s_mov_b32 s23, 0x20000
    s_mov_b32 s24, s8
    s_mov_b32 s25, s9
    s_mov_b32 s26, 0x200000
    s_mov_b32 s27, 0x20000
    s_lshl_b32 s36, s12, 11
    s_add_u32 s36, s36, 86016
    s_lshl_b32 s37, s13, 11
    s_mov_b32 m0, s36
    s_nop 0
    buffer_load_dwordx4 v8, s[20:23], s37 offen lds
    buffer_load_dwordx4 v8, s[20:23], s37 offen offset:1024 lds
    s_mov_b32 s38, 2048
    s_mov_b32 s39, 4096
    v_mov_b32 v155, v6
    v_mov_b32 v159, v7
    v_lshlrev_b32 v9, 3, v4
    v_sub_u32 v9, v3, v9
    s_mov_b32 s40, 0x3f80
    v_subrev_u32 v10, 0, v9
    v_cmp_gt_u32 vcc, 2, v10
    v_lshlrev_b32 v11, 4, v10
    v_lshlrev_b32 v11, v11, s40
    v_cndmask_b32 v48, 0, v11, vcc
    v_subrev_u32 v10, 2, v9
    v_cmp_gt_u32 vcc, 2, v10
    v_lshlrev_b32 v11, 4, v10
    v_lshlrev_b32 v11, v11, s40
    v_cndmask_b32 v49, 0, v11, vcc
    v_subrev_u32 v10, 4, v9
    v_cmp_gt_u32 vcc, 2, v10
    v_lshlrev_b32 v11, 4, v10
    v_lshlrev_b32 v11, v11, s40
    v_cndmask_b32 v50, 0, v11, vcc
    v_subrev_u32 v10, 6, v9
    v_cmp_gt_u32 vcc, 2, v10
    v_lshlrev_b32 v11, 4, v10
    v_lshlrev_b32 v11, v11, s40
    v_cndmask_b32 v51, 0, v11, vcc
    v_subrev_u32 v10, 16, v9
    v_cmp_gt_u32 vcc, 2, v10
    v_lshlrev_b32 v11, 4, v10
    v_lshlrev_b32 v11, v11, s40
    v_cndmask_b32 v52, 0, v11, vcc
    v_subrev_u32 v10, 18, v9
    v_cmp_gt_u32 vcc, 2, v10
    v_lshlrev_b32 v11, 4, v10
    v_lshlrev_b32 v11, v11, s40
    v_cndmask_b32 v53, 0, v11, vcc
    v_subrev_u32 v10, 20, v9
    v_cmp_gt_u32 vcc, 2, v10
    v_lshlrev_b32 v11, 4, v10
    v_lshlrev_b32 v11, v11, s40
    v_cndmask_b32 v54, 0, v11, vcc
    v_subrev_u32 v10, 22, v9
    v_cmp_gt_u32 vcc, 2, v10
    v_lshlrev_b32 v11, 4, v10
    v_lshlrev_b32 v11, v11, s40
    v_cndmask_b32 v55, 0, v11, vcc
    v_and_b32 v10, 15, v2
    v_lshrrev_b32 v11, 2, v10
    v_lshl_add_u32 v11, v4, 3, v11
    v_lshlrev_b32 v11, 6, v11
    v_and_b32 v10, 3, v10
    v_lshlrev_b32 v10, 3, v10
    v_bfe_u32 v12, v2, 4, 1
    v_lshl_add_u32 v10, v12, 5, v10
    v_add_u32 v11, v11, v10
    v_add_u32 v11, s36, v11
    s_barrier
    v_mov_b32 v156, v8
    v_mov_b32 v157, v11
    v_mov_b32 v158, v3
    s_mov_b32 s59, s13
    s_mov_b32 s60, s14
    buffer_load_dwordx4 v[176:179], v155, s[16:19], 0 offen offset:0
    buffer_load_dwordx4 v[180:183], v155, s[16:19], 0 offen offset:32
    buffer_load_dwordx4 v[136:139], v155, s[16:19], s38 offen offset:0
    buffer_load_dwordx4 v[140:143], v155, s[16:19], s38 offen offset:32
    buffer_load_dwordx4 v[220:223], v155, s[16:19], s39 offen offset:0
    buffer_load_dwordx4 v[224:227], v155, s[16:19], s39 offen offset:32
    s_load_dwordx2 s[46:47], s[0:1], 0
    s_and_b32 s36, s2, 7
    s_lshr_b32 s37, s2, 3
    s_and_b32 s38, s36, 3
    s_lshl_b32 s38, s38, 2
    s_and_b32 s39, s37, 3
    s_add_u32 s38, s38, s39
    s_lshr_b32 s39, s36, 2
    s_lshl_b32 s39, s39, 3
    s_lshr_b32 s41, s37, 2
    s_add_u32 s39, s39, s41
    v_and_b32 v2, 63, v0
    v_lshrrev_b32 v3, 4, v2
    v_lshlrev_b32 v3, 2, v3
    v_and_b32 v7, 3, v2
    v_add_u32 v3, v3, v7
    s_lshl_b32 s41, s70, 4
    v_add_u32 v3, s41, v3
    v_bfe_u32 v7, v2, 2, 2
    v_mul_u32_u24 v6, 272, v3
    v_lshl_add_u32 v6, v7, 6, v6
    v_lshlrev_b32 v5, 3, v3
    s_lshl_b32 s41, s38, 7
    v_add_u32 v3, s41, v3
    v_lshlrev_b32 v4, 11, v3
    v_lshl_add_u32 v4, v7, 5, v4
    s_lshl_b32 s41, s39, 7
    v_add_u32 v4, s41, v4
    s_waitcnt lgkmcnt(0)
    s_mov_b32 s48, s46
    s_mov_b32 s49, s47
    s_mov_b32 s50, 0x400000
    s_mov_b32 s51, 0x20000
    buffer_load_dwordx4 v[232:235], v4, s[48:51], 0 offen
    buffer_load_dwordx4 v[236:239], v4, s[48:51], 0 offen offset:16
    v_mov_b32 v8, v156
    v_mov_b32 v11, v157
    v_mov_b32 v3, v158
    s_mov_b32 s13, s59
    s_mov_b32 s14, s60
    buffer_load_dwordx4 v[212:215], v159, s[24:27], 0 offen offset:0
    buffer_load_dwordx4 v[216:219], v159, s[24:27], 0 offen offset:32
    s_waitcnt vmcnt(4)
    s_add_u32 s28, s68, 0x2000000
    s_addc_u32 s29, s69, 0
    s_mov_b32 s30, 0x600000
    s_mov_b32 s31, 0x20000
    s_add_u32 s32, s68, 0x2600000
    s_addc_u32 s33, s69, 0
    s_mov_b32 s34, 0x200000
    s_mov_b32 s35, 0x20000
    ds_read_b64_tr_b16 v[56:57], v11 offset:0
    ds_read_b64_tr_b16 v[58:59], v11 offset:256
    ds_read_b64_tr_b16 v[60:61], v11 offset:1024
    ds_read_b64_tr_b16 v[62:63], v11 offset:1280
    s_mul_i32 s41, s13, 196608
    s_mul_i32 s42, s14, 6144
    s_add_u32 s41, s41, s42
    s_lshr_b32 s42, s13, 1
    s_lshl_b32 s42, s42, 17
    s_lshl_b32 s43, s14, 12
    s_add_u32 s42, s42, s43
    s_and_b32 s43, s13, 1
    s_lshl_b32 s43, s43, 10
    s_add_u32 s42, s42, s43
    v_mov_b32 v160, 0x3f803f80
    v_mov_b32 v161, 0x3f803f80
    v_mov_b32 v162, 0x3f803f80
    v_mov_b32 v163, 0x3f803f80
    s_waitcnt lgkmcnt(0)
    s_add_u32 s20, s68, 0x2b00000
    s_addc_u32 s21, s69, 0
    s_mov_b32 s22, 0x60000
    s_mov_b32 s23, 0x20000
    s_lshl_b32 s45, s13, 5
    s_add_u32 s45, s45, s14
    s_mul_i32 s45, s45, 384
    v_lshlrev_b32 v9, 2, v3
    v_mfma_f32_32x32x16_bf16 v[64:79], v[176:179], v[56:59], 0
    v_mfma_f32_32x32x16_bf16 v[64:79], v[180:183], v[60:63], v[64:79]
    v_mfma_f32_32x32x16_bf16 v[80:95], v[136:139], v[56:59], 0
    v_mfma_f32_32x32x16_bf16 v[80:95], v[140:143], v[60:63], v[80:95]
    v_mfma_f32_32x32x16_bf16 v[96:111], v[220:223], v[48:51], 0
    v_mfma_f32_32x32x16_bf16 v[96:111], v[224:227], v[52:55], v[96:111]
    s_nop 7
    v_cvt_pk_bf16_f32 v128, v64, v65
    v_cvt_pk_bf16_f32 v129, v66, v67
    v_cvt_pk_bf16_f32 v130, v68, v69
    v_cvt_pk_bf16_f32 v131, v70, v71
    v_cvt_pk_bf16_f32 v132, v72, v73
    v_cvt_pk_bf16_f32 v133, v74, v75
    v_cvt_pk_bf16_f32 v134, v76, v77
    v_cvt_pk_bf16_f32 v135, v78, v79
    s_add_u32 s44, s41, 0
    buffer_store_dwordx4 v[128:131], v8, s[28:31], s44 offen sc1
    s_add_u32 s44, s41, 3072
    buffer_store_dwordx4 v[132:135], v8, s[28:31], s44 offen sc1
    v_mfma_f32_32x32x16_bf16 v[164:179], v[160:163], v[128:131], 0
    v_mfma_f32_32x32x16_bf16 v[164:179], v[160:163], v[132:135], v[164:179]
    v_cvt_pk_bf16_f32 v136, v80, v81
    v_cvt_pk_bf16_f32 v137, v82, v83
    v_cvt_pk_bf16_f32 v138, v84, v85
    v_cvt_pk_bf16_f32 v139, v86, v87
    v_cvt_pk_bf16_f32 v140, v88, v89
    v_cvt_pk_bf16_f32 v141, v90, v91
    v_cvt_pk_bf16_f32 v142, v92, v93
    v_cvt_pk_bf16_f32 v143, v94, v95
    s_add_u32 s44, s41, 1024
    buffer_store_dwordx4 v[136:139], v8, s[28:31], s44 offen sc1
    s_add_u32 s44, s41, 4096
    buffer_store_dwordx4 v[140:143], v8, s[28:31], s44 offen sc1
    v_mfma_f32_32x32x16_bf16 v[180:195], v[160:163], v[136:139], 0
    v_mfma_f32_32x32x16_bf16 v[180:195], v[160:163], v[140:143], v[180:195]
    v_cvt_pk_bf16_f32 v144, v96, v97
    v_cvt_pk_bf16_f32 v145, v98, v99
    v_cvt_pk_bf16_f32 v146, v100, v101
    v_cvt_pk_bf16_f32 v147, v102, v103
    v_cvt_pk_bf16_f32 v148, v104, v105
    v_cvt_pk_bf16_f32 v149, v106, v107
    v_cvt_pk_bf16_f32 v150, v108, v109
    v_cvt_pk_bf16_f32 v151, v110, v111
    s_add_u32 s44, s41, 2048
    buffer_store_dwordx4 v[144:147], v8, s[28:31], s44 offen sc1
    s_add_u32 s44, s41, 5120
    buffer_store_dwordx4 v[148:151], v8, s[28:31], s44 offen sc1
    v_mfma_f32_32x32x16_bf16 v[196:211], v[160:163], v[144:147], 0
    v_mfma_f32_32x32x16_bf16 v[196:211], v[160:163], v[148:151], v[196:211]
    s_waitcnt vmcnt(6)
    v_mfma_f32_32x32x16_bf16 v[112:127], v[212:215], v[48:51], 0
    v_mfma_f32_32x32x16_bf16 v[112:127], v[216:219], v[52:55], v[112:127]
    s_nop 11
    v_cvt_pk_bf16_f32 v152, v112, v113
    v_cvt_pk_bf16_f32 v153, v114, v115
    v_cvt_pk_bf16_f32 v154, v116, v117
    v_cvt_pk_bf16_f32 v155, v118, v119
    v_cvt_pk_bf16_f32 v156, v120, v121
    v_cvt_pk_bf16_f32 v157, v122, v123
    v_cvt_pk_bf16_f32 v158, v124, v125
    v_cvt_pk_bf16_f32 v159, v126, v127
    s_add_u32 s44, s42, 0
    buffer_store_dwordx4 v[152:155], v8, s[32:35], s44 offen sc1
    s_add_u32 s44, s42, 2048
    buffer_store_dwordx4 v[156:159], v8, s[32:35], s44 offen sc1
    s_mov_b32 exec_lo, -1
    s_mov_b32 exec_hi, 0
    buffer_store_dword v164, v9, s[20:23], s45 offen offset:0 sc1
    buffer_store_dword v180, v9, s[20:23], s45 offen offset:128 sc1
    buffer_store_dword v196, v9, s[20:23], s45 offen offset:256 sc1
    s_mov_b64 exec, -1
    s_add_u32 s16, s68, 0x1c00000
    s_addc_u32 s17, s69, 0
    s_mov_b32 s18, 0x400000
    s_mov_b32 s19, 0x20000
    v_mov_b32 v60, -1
    v_mov_b32 v61, -1
    v_mov_b32 v62, -1
    v_mov_b32 v63, -1
    s_and_b32 s36, s2, 7
    s_lshl_b32 s36, s36, 5
    s_add_u32 s36, s36, s14
    s_sub_u32 s12, s70, 4
    s_lshr_b32 s37, s12, 1
    s_lshl_b32 s37, s37, 21
    s_lshl_b32 s38, s36, 12
    s_add_u32 s38, s38, s37
    s_and_b32 s39, s12, 1
    s_lshl_b32 s39, s39, 11
    s_add_u32 s38, s38, s39
    buffer_store_dwordx4 v[60:63], v8, s[16:19], s38 offen sc1
    buffer_store_dwordx4 v[60:63], v8, s[16:19], s38 offen offset:1024 sc1
    s_lshl_b32 s38, s36, 8
    s_add_u32 s38, s38, s37
    s_add_u32 s38, s38, 1048576
    v_lshlrev_b32 v9, 2, v2
    buffer_store_dword v60, v9, s[16:19], s38 offen sc1
    s_waitcnt vmcnt(14)
    s_and_b32 s36, s2, 7
    s_lshr_b32 s37, s2, 3
    s_and_b32 s38, s36, 3
    s_lshl_b32 s38, s38, 2
    s_and_b32 s39, s37, 3
    s_add_u32 s38, s38, s39
    s_lshr_b32 s39, s36, 2
    s_lshl_b32 s39, s39, 3
    s_lshr_b32 s41, s37, 2
    s_add_u32 s39, s39, s41
    v_and_b32 v2, 63, v0
    v_lshrrev_b32 v3, 4, v2
    v_lshlrev_b32 v3, 2, v3
    v_and_b32 v7, 3, v2
    v_add_u32 v3, v3, v7
    s_lshl_b32 s41, s70, 4
    v_add_u32 v3, s41, v3
    v_bfe_u32 v7, v2, 2, 2
    v_mul_u32_u24 v6, 272, v3
    v_lshl_add_u32 v6, v7, 6, v6
    v_lshlrev_b32 v5, 3, v3
    s_lshl_b32 s41, s38, 7
    v_add_u32 v3, s41, v3
    v_lshlrev_b32 v4, 11, v3
    v_lshl_add_u32 v4, v7, 5, v4
    s_lshl_b32 s41, s39, 7
    v_add_u32 v4, s41, v4
    s_mov_b32 s40, 0xffff0000
    s_add_u32 s28, s68, 0x2a00000
    s_addc_u32 s29, s69, 0
    s_mov_b32 s30, 0x100000
    s_mov_b32 s31, 0x20000
    v_lshlrev_b32 v16, 16, v232
    v_and_b32 v17, s40, v232
    v_lshlrev_b32 v18, 16, v233
    v_and_b32 v19, s40, v233
    v_lshlrev_b32 v20, 16, v234
    v_and_b32 v21, s40, v234
    v_lshlrev_b32 v22, 16, v235
    v_and_b32 v23, s40, v235
    v_lshlrev_b32 v24, 16, v236
    v_and_b32 v25, s40, v236
    v_lshlrev_b32 v26, 16, v237
    v_and_b32 v27, s40, v237
    v_lshlrev_b32 v28, 16, v238
    v_and_b32 v29, s40, v238
    v_lshlrev_b32 v30, 16, v239
    v_and_b32 v31, s40, v239
    s_mov_b32 s43, 0
    v_pk_add_f32 v[32:33], v[16:17], v[18:19]
    v_pk_mul_f32 v[34:35], v[16:17], v[16:17]
    v_pk_add_f32 v[36:37], v[20:21], v[22:23]
    v_pk_mul_f32 v[38:39], v[18:19], v[18:19]
    v_pk_fma_f32 v[34:35], v[20:21], v[20:21], v[34:35]
    v_pk_fma_f32 v[38:39], v[22:23], v[22:23], v[38:39]
    v_pk_fma_f32 v[34:35], v[24:25], v[24:25], v[34:35]
    v_pk_fma_f32 v[38:39], v[26:27], v[26:27], v[38:39]
    v_pk_add_f32 v[32:33], v[32:33], v[24:25]
    v_pk_add_f32 v[32:33], v[32:33], v[26:27]
    v_pk_fma_f32 v[34:35], v[28:29], v[28:29], v[34:35]
    v_pk_fma_f32 v[38:39], v[30:31], v[30:31], v[38:39]
    v_pk_add_f32 v[36:37], v[36:37], v[28:29]
    v_pk_add_f32 v[36:37], v[36:37], v[30:31]
    v_pk_add_f32 v[32:33], v[32:33], v[36:37]
    v_pk_add_f32 v[34:35], v[34:35], v[38:39]
    v_add_f32 v32, v32, v33
    v_add_f32 v33, v34, v35
    s_nop 0
    v_add_f32_dpp v32, v32, v32 row_ror:4 row_mask:0xf bank_mask:0xf
    v_add_f32_dpp v33, v33, v33 row_ror:4 row_mask:0xf bank_mask:0xf
    s_nop 0
    v_add_f32_dpp v32, v32, v32 row_ror:8 row_mask:0xf bank_mask:0xf
    v_add_f32_dpp v33, v33, v33 row_ror:8 row_mask:0xf bank_mask:0xf
    s_lshl_b32 s42, s38, 4
    s_add_u32 s42, s42, s39
    s_lshl_b32 s42, s42, 10
    s_add_u32 s42, s42, s43
    s_mov_b32 exec_lo, 0x000f000f
    s_mov_b32 exec_hi, 0x000f000f
    buffer_store_dwordx2 v[32:33], v5, s[28:31], s42 offen sc1
    s_mov_b64 exec, -1
    s_waitcnt vmcnt(0)
    v_mov_b32 v250, 137688
    v_mov_b32 v251, 1
    s_mov_b64 exec, 1
    ds_add_u32 v250, v251
    s_mov_b64 exec, -1
    s_branch L_interleave_layers__ssm_conv_h3__linear_hedgehog__prompt_cjoin2_4
L_interleave_layers__ssm_conv_h3__linear_hedgehog__prompt_cjoin_3:
    s_waitcnt vmcnt(0)
    v_mov_b32 v250, 137684
    v_mov_b32 v251, 1
    s_mov_b64 exec, 1
    ds_add_u32 v250, v251
    s_mov_b64 exec, -1
    v_mov_b32 v250, 137688
    v_mov_b32 v251, 1
    s_mov_b64 exec, 1
    ds_add_u32 v250, v251
    s_mov_b64 exec, -1
    s_cmp_eq_u32 s70, 0
    s_cbranch_scc0 L_interleave_layers__ssm_conv_h3__linear_hedgehog__prompt_f1_12
    v_mov_b32 v250, 137684
    s_mov_b32 s62, 0
L_interleave_layers__ssm_conv_h3__linear_hedgehog__prompt_lw_14:
    ds_read_b32 v251, v250
    s_waitcnt lgkmcnt(0)
    v_readfirstlane_b32 s61, v251
    s_nop 3
    s_cmp_ge_u32 s61, 4
    s_cbranch_scc1 L_interleave_layers__ssm_conv_h3__linear_hedgehog__prompt_lwd_15
    s_add_u32 s62, s62, 1
    s_cmp_lt_u32 s62, 0x100000
    s_cbranch_scc1 L_interleave_layers__ssm_conv_h3__linear_hedgehog__prompt_lw_14
L_interleave_layers__ssm_conv_h3__linear_hedgehog__prompt_lwd_15:
    s_lshl_b32 s36, s10, 7
    v_mov_b32 v253, 0
    v_mov_b32 v254, s73
    s_mov_b64 exec, 1
    buffer_store_dword v254, v253, s[64:67], s36 offen sc1
    s_mov_b64 exec, -1
L_interleave_layers__ssm_conv_h3__linear_hedgehog__prompt_sf_16:
L_interleave_layers__ssm_conv_h3__linear_hedgehog__prompt_f1_12:
    s_cmp_eq_u32 s70, 1
    s_cbranch_scc0 L_interleave_layers__ssm_conv_h3__linear_hedgehog__prompt_f2_13
    v_mov_b32 v250, 137688
    s_mov_b32 s62, 0
L_interleave_layers__ssm_conv_h3__linear_hedgehog__prompt_lw_17:
    ds_read_b32 v251, v250
    s_waitcnt lgkmcnt(0)
    v_readfirstlane_b32 s61, v251
    s_nop 3
    s_cmp_ge_u32 s61, 8
    s_cbranch_scc1 L_interleave_layers__ssm_conv_h3__linear_hedgehog__prompt_lwd_18
    s_add_u32 s62, s62, 1
    s_cmp_lt_u32 s62, 0x100000
    s_cbranch_scc1 L_interleave_layers__ssm_conv_h3__linear_hedgehog__prompt_lw_17
L_interleave_layers__ssm_conv_h3__linear_hedgehog__prompt_lwd_18:
    s_and_b32 s36, s2, 7
    s_lshr_b32 s37, s2, 3
    s_and_b32 s38, s36, 3
    s_lshl_b32 s38, s38, 2
    s_and_b32 s39, s37, 3
    s_add_u32 s38, s38, s39
    s_lshr_b32 s39, s36, 2
    s_lshl_b32 s39, s39, 3
    s_lshr_b32 s41, s37, 2
    s_add_u32 s39, s39, s41
    v_and_b32 v2, 63, v0
    v_lshrrev_b32 v3, 4, v2
    v_lshlrev_b32 v3, 2, v3
    v_and_b32 v7, 3, v2
    v_add_u32 v3, v3, v7
    s_lshl_b32 s41, s70, 4
    v_add_u32 v3, s41, v3
    v_bfe_u32 v7, v2, 2, 2
    v_mul_u32_u24 v6, 272, v3
    v_lshl_add_u32 v6, v7, 6, v6
    v_lshlrev_b32 v5, 3, v3
    s_lshl_b32 s41, s38, 7
    v_add_u32 v3, s41, v3
    v_lshlrev_b32 v4, 11, v3
    v_lshl_add_u32 v4, v7, 5, v4
    s_lshl_b32 s41, s39, 7
    v_add_u32 v4, s41, v4
    s_lshl_b32 s36, s38, 4
    s_add_u32 s36, s36, s39
    s_lshl_b32 s36, s36, 7
    s_add_u32 s36, s36, 32768
    v_mov_b32 v253, 0
    v_mov_b32 v254, s73
    s_mov_b64 exec, 1
    buffer_store_dword v254, v253, s[64:67], s36 offen sc1
    s_mov_b64 exec, -1
L_interleave_layers__ssm_conv_h3__linear_hedgehog__prompt_sf_19:
L_interleave_layers__ssm_conv_h3__linear_hedgehog__prompt_f2_13:
L_interleave_layers__ssm_conv_h3__linear_hedgehog__prompt_cjoin2_4:
L_interleave_layers__ssm_conv_h3__linear_hedgehog__prompt_layer_20:
    s_and_b32 s36, s2, 7
    s_lshr_b32 s37, s2, 3
    s_and_b32 s38, s36, 3
    s_lshl_b32 s38, s38, 2
    s_and_b32 s39, s37, 3
    s_add_u32 s38, s38, s39
    s_lshr_b32 s39, s36, 2
    s_lshl_b32 s39, s39, 3
    s_lshr_b32 s41, s37, 2
    s_add_u32 s39, s39, s41
    v_and_b32 v2, 63, v0
    v_lshrrev_b32 v3, 4, v2
    v_lshlrev_b32 v3, 2, v3
    v_and_b32 v7, 3, v2
    v_add_u32 v3, v3, v7
    s_lshl_b32 s41, s70, 4
    v_add_u32 v3, s41, v3
    v_bfe_u32 v7, v2, 2, 2
    v_mul_u32_u24 v6, 272, v3
    v_lshl_add_u32 v6, v7, 6, v6
    v_lshlrev_b32 v5, 3, v3
    s_lshl_b32 s41, s38, 7
    v_add_u32 v3, s41, v3
    v_lshlrev_b32 v4, 11, v3
    v_lshl_add_u32 v4, v7, 5, v4
    s_lshl_b32 s41, s39, 7
    v_add_u32 v4, s41, v4
    s_mov_b32 s40, 0xffff0000
    s_add_u32 s28, s68, 0x2a00000
    s_addc_u32 s29, s69, 0
    s_mov_b32 s30, 0x100000
    s_mov_b32 s31, 0x20000
    s_mul_i32 s26, s71, 0x2800000
    s_add_u32 s26, s26, 0xc00000
    s_add_u32 s24, s68, s26
    s_addc_u32 s25, s69, 0
    s_mov_b32 s26, 0x400000
    s_mov_b32 s27, 0x20000
    s_lshl_b32 s43, s71, 19
    s_add_u32 s44, s43, 262144
    v_lshlrev_b32 v16, 16, v232
    v_and_b32 v17, s40, v232
    v_lshlrev_b32 v18, 16, v233
    v_and_b32 v19, s40, v233
    v_lshlrev_b32 v20, 16, v234
    v_and_b32 v21, s40, v234
    v_lshlrev_b32 v22, 16, v235
    v_and_b32 v23, s40, v235
    v_lshlrev_b32 v24, 16, v236
    v_and_b32 v25, s40, v236
    v_lshlrev_b32 v26, 16, v237
    v_and_b32 v27, s40, v237
    v_lshlrev_b32 v28, 16, v238
    v_and_b32 v29, s40, v238
    v_lshlrev_b32 v30, 16, v239
    v_and_b32 v31, s40, v239
    s_mul_i32 s48, s71, 98304
    s_add_u32 s48, s48, 32768
    s_cmp_eq_u32 s71, 0
    s_cbranch_scc1 L_interleave_layers__ssm_conv_h3__linear_hedgehog__prompt_ly_21
    v_pk_add_f32 v[32:33], v[16:17], v[18:19]
    v_pk_mul_f32 v[34:35], v[16:17], v[16:17]
    v_pk_add_f32 v[36:37], v[20:21], v[22:23]
    v_pk_mul_f32 v[38:39], v[18:19], v[18:19]
    v_pk_fma_f32 v[34:35], v[20:21], v[20:21], v[34:35]
    v_pk_fma_f32 v[38:39], v[22:23], v[22:23], v[38:39]
    v_pk_fma_f32 v[34:35], v[24:25], v[24:25], v[34:35]
    v_pk_fma_f32 v[38:39], v[26:27], v[26:27], v[38:39]
    v_pk_add_f32 v[32:33], v[32:33], v[24:25]
    v_pk_add_f32 v[32:33], v[32:33], v[26:27]
    v_pk_fma_f32 v[34:35], v[28:29], v[28:29], v[34:35]
    v_pk_fma_f32 v[38:39], v[30:31], v[30:31], v[38:39]
    v_pk_add_f32 v[36:37], v[36:37], v[28:29]
    v_pk_add_f32 v[36:37], v[36:37], v[30:31]
    v_pk_add_f32 v[32:33], v[32:33], v[36:37]
    v_pk_add_f32 v[34:35], v[34:35], v[38:39]
    v_add_f32 v32, v32, v33
    v_add_f32 v33, v34, v35
    s_nop 0
    v_add_f32_dpp v32, v32, v32 row_ror:4 row_mask:0xf bank_mask:0xf
    v_add_f32_dpp v33, v33, v33 row_ror:4 row_mask:0xf bank_mask:0xf
    s_nop 0
    v_add_f32_dpp v32, v32, v32 row_ror:8 row_mask:0xf bank_mask:0xf
    v_add_f32_dpp v33, v33, v33 row_ror:8 row_mask:0xf bank_mask:0xf
    s_lshl_b32 s42, s38, 4
    s_add_u32 s42, s42, s39
    s_lshl_b32 s42, s42, 10
    s_add_u32 s42, s42, s43
    s_mov_b32 exec_lo, 0x000f000f
    s_mov_b32 exec_hi, 0x000f000f
    buffer_store_dwordx2 v[32:33], v5, s[28:31], s42 offen sc1
    s_mov_b64 exec, -1
    s_waitcnt vmcnt(0)
    s_barrier
    s_lshl_b32 s45, s38, 4
    s_add_u32 s46, s45, s39
    s_lshl_b32 s46, s46, 7
    s_add_u32 s46, s46, s48
    s_cmp_eq_u32 s70, 0
    s_cbranch_scc0 L_interleave_layers__ssm_conv_h3__linear_hedgehog__prompt_sf_23
    v_mov_b32 v253, 0
    v_mov_b32 v254, s73
    s_mov_b64 exec, 1
    buffer_store_dword v254, v253, s[64:67], s46 offen sc1
    s_mov_b64 exec, -1
L_interleave_layers__ssm_conv_h3__linear_hedgehog__prompt_sf_23:
    s_lshl_b32 s45, s45, 7
    s_add_u32 s45, s45, s48
    s_cmp_eq_u32 s70, 0
    s_cbranch_scc0 L_interleave_layers__ssm_conv_h3__linear_hedgehog__prompt_np_24
    v_and_b32 v253, 63, v0
    v_lshlrev_b32 v253, 7, v253
    s_mov_b32 exec_lo, 0xffff
    s_mov_b32 exec_hi, 0
    s_mov_b32 s62, 0
L_interleave_layers__ssm_conv_h3__linear_hedgehog__prompt_pl_25:
    buffer_load_dword v248, v253, s[64:67], s45 offen sc1
    s_waitcnt vmcnt(0)
    v_cmp_eq_u32 vcc, s73, v248
    s_nop 3
    s_cmp_eq_u64 vcc, exec
    s_cbranch_scc1 L_interleave_layers__ssm_conv_h3__linear_hedgehog__prompt_pd_26
    s_sleep 1
    s_add_u32 s62, s62, 1
    s_cmp_lt_u32 s62, 0x10000
    s_cbranch_scc1 L_interleave_layers__ssm_conv_h3__linear_hedgehog__prompt_pl_25
L_interleave_layers__ssm_conv_h3__linear_hedgehog__prompt_pd_26:
    s_mov_b64 exec, -1
L_interleave_layers__ssm_conv_h3__linear_hedgehog__prompt_np_24:
    s_barrier
    s_branch L_interleave_layers__ssm_conv_h3__linear_hedgehog__prompt_lz_22
L_interleave_layers__ssm_conv_h3__linear_hedgehog__prompt_ly_21:
    s_lshl_b32 s45, s39, 11
    s_add_u32 s45, s45, 0
    s_cmp_eq_u32 s70, 0
    s_cbranch_scc0 L_interleave_layers__ssm_conv_h3__linear_hedgehog__prompt_np_27
    v_and_b32 v253, 63, v0
    v_lshlrev_b32 v253, 7, v253
    s_mov_b32 exec_lo, 0xffff
    s_mov_b32 exec_hi, 0
    s_mov_b32 s62, 0
L_interleave_layers__ssm_conv_h3__linear_hedgehog__prompt_pl_28:
    buffer_load_dword v248, v253, s[64:67], s45 offen sc1
    s_waitcnt vmcnt(0)
    v_cmp_eq_u32 vcc, s73, v248
    s_nop 3
    s_cmp_eq_u64 vcc, exec
    s_cbranch_scc1 L_interleave_layers__ssm_conv_h3__linear_hedgehog__prompt_pd_29
    s_sleep 1
    s_add_u32 s62, s62, 1
    s_cmp_lt_u32 s62, 0x10000
    s_cbranch_scc1 L_interleave_layers__ssm_conv_h3__linear_hedgehog__prompt_pl_28
L_interleave_layers__ssm_conv_h3__linear_hedgehog__prompt_pd_29:
    s_mov_b64 exec, -1
L_interleave_layers__ssm_conv_h3__linear_hedgehog__prompt_np_27:
    s_lshl_b32 s45, s38, 11
    s_add_u32 s45, s45, s48
    s_cmp_eq_u32 s70, 1
    s_cbranch_scc0 L_interleave_layers__ssm_conv_h3__linear_hedgehog__prompt_np_30
    v_and_b32 v253, 63, v0
    v_lshlrev_b32 v253, 7, v253
    s_mov_b32 exec_lo, 0xffff
    s_mov_b32 exec_hi, 0
    s_mov_b32 s62, 0
L_interleave_layers__ssm_conv_h3__linear_hedgehog__prompt_pl_31:
    buffer_load_dword v248, v253, s[64:67], s45 offen sc1
    s_waitcnt vmcnt(0)
    v_cmp_eq_u32 vcc, s73, v248
    s_nop 3
    s_cmp_eq_u64 vcc, exec
    s_cbranch_scc1 L_interleave_layers__ssm_conv_h3__linear_hedgehog__prompt_pd_32
    s_sleep 1
    s_add_u32 s62, s62, 1
    s_cmp_lt_u32 s62, 0x10000
    s_cbranch_scc1 L_interleave_layers__ssm_conv_h3__linear_hedgehog__prompt_pl_31
L_interleave_layers__ssm_conv_h3__linear_hedgehog__prompt_pd_32:
    s_mov_b64 exec, -1
L_interleave_layers__ssm_conv_h3__linear_hedgehog__prompt_np_30:
    s_add_u32 s16, s68, 0x400000
    s_addc_u32 s17, s69, 0
    s_mov_b32 s18, 0x400000
    s_mov_b32 s19, 0x20000
    s_barrier
    v_lshlrev_b32 v8, 4, v2
    s_lshl_b32 s45, s38, 3
    s_add_u32 s45, s45, s70
    s_lshl_b32 s45, s45, 15
    s_lshl_b32 s46, s39, 11
    s_add_u32 s45, s45, s46
    s_lshl_b32 s47, s70, 11
    s_mov_b32 m0, s47
    s_nop 0
    buffer_load_dwordx4 v8, s[16:19], s45 offen sc1 lds
    buffer_load_dwordx4 v8, s[16:19], s45 offen offset:1024 sc1 lds
L_interleave_layers__ssm_conv_h3__linear_hedgehog__prompt_lz_22:
    v_lshrrev_b32 v7, 3, v2
    v_lshlrev_b32 v7, 10, v7
    v_and_b32 v8, 7, v2
    v_lshl_add_u32 v7, v8, 4, v7
    s_lshl_b32 s45, s38, 14
    s_add_u32 s45, s45, s43
    s_lshl_b32 s46, s70, 7
    s_add_u32 s45, s45, s46
    s_add_u32 s46, s45, 8192
    s_mov_b32 s62, 0
L_interleave_layers__ssm_conv_h3__linear_hedgehog__prompt_sc_33:
    buffer_load_dwordx4 v[40:43], v7, s[28:31], s45 offen sc1
    buffer_load_dwordx4 v[44:47], v7, s[28:31], s46 offen sc1
L_interleave_layers__ssm_conv_h3__linear_hedgehog__prompt_scd_34:
    s_lshl_b32 s46, s70, 7
    s_add_u32 s46, s46, 137728
    v_lshl_add_u32 v8, v8, 4, s46
    v_lshrrev_b32 v9, 4, v2
    v_lshlrev_b32 v9, 2, v9
    v_and_b32 v10, 3, v2
    v_add_u32 v9, v9, v10
    v_lshl_add_u32 v9, v9, 3, s46
    s_waitcnt vmcnt(0)
    s_cmp_eq_u32 s71, 0
    s_cbranch_scc0 L_interleave_layers__ssm_conv_h3__linear_hedgehog__prompt_yt_35
    v_and_b32 v11, 3, v2
    v_lshlrev_b32 v12, 9, v11
    v_bfe_u32 v11, v2, 2, 2
    v_lshl_add_u32 v12, v11, 5, v12
    v_lshrrev_b32 v11, 4, v2
    v_lshl_add_u32 v12, v11, 3, v12
    s_lshl_b32 s47, s70, 11
    v_add_u32 v12, s47, v12
    ds_read_b64_tr_b16 v[240:241], v12 offset:0
    ds_read_b64_tr_b16 v[242:243], v12 offset:128
    ds_read_b64_tr_b16 v[244:245], v12 offset:256
    ds_read_b64_tr_b16 v[246:247], v12 offset:384
L_interleave_layers__ssm_conv_h3__linear_hedgehog__prompt_yt_35:
    v_pk_add_f32 v[40:41], v[40:41], v[44:45]
    v_pk_add_f32 v[42:43], v[42:43], v[46:47]
    s_nop 0
    v_add_f32_dpp v40, v40, v40 row_ror:8 row_mask:0xf bank_mask:0xf
    v_add_f32_dpp v41, v41, v41 row_ror:8 row_mask:0xf bank_mask:0xf
    v_add_f32_dpp v42, v42, v42 row_ror:8 row_mask:0xf bank_mask:0xf
    v_add_f32_dpp v43, v43, v43 row_ror:8 row_mask:0xf bank_mask:0xf
    v_mov_b32 v44, v40
    v_mov_b32 v45, v41
    v_mov_b32 v46, v42
    v_mov_b32 v47, v43
    v_permlane16_swap_b32 v40, v44
    v_permlane16_swap_b32 v41, v45
    v_permlane16_swap_b32 v42, v46
    v_permlane16_swap_b32 v43, v47
    v_add_f32 v40, v40, v44
    v_add_f32 v41, v41, v45
    v_add_f32 v42, v42, v46
    v_add_f32 v43, v43, v47
    v_mov_b32 v44, v40
    v_mov_b32 v45, v41
    v_mov_b32 v46, v42
    v_mov_b32 v47, v43
    v_permlane32_swap_b32 v40, v44
    v_permlane32_swap_b32 v41, v45
    v_permlane32_swap_b32 v42, v46
    v_permlane32_swap_b32 v43, v47
    v_add_f32 v40, v40, v44
    v_add_f32 v41, v41, v45
    v_add_f32 v42, v42, v46
    v_add_f32 v43, v43, v47
    v_mul_f32 v40, 0x3a800000, v40
    v_mul_f32 v41, 0x3a800000, v41
    v_fma_f32 v41, -v40, v40, v41
    v_max_f32 v41, 0, v41
    v_add_f32 v41, 0x3727c5ac, v41
    v_rsq_f32 v41, v41
    v_mul_f32 v42, 0x3a800000, v42
    v_mul_f32 v43, 0x3a800000, v43
    v_fma_f32 v43, -v42, v42, v43
    v_max_f32 v43, 0, v43
    v_add_f32 v43, 0x3727c5ac, v43
    v_rsq_f32 v43, v43
    s_mov_b64 exec, 0xff
    ds_write_b128 v8, v[40:43]
    s_mov_b64 exec, -1
    s_waitcnt lgkmcnt(0)
    ds_read_b64 v[32:33], v9
    s_waitcnt lgkmcnt(0)
    v_lshlrev_b32 v48, 16, v240
    v_and_b32 v49, s40, v240
    v_lshlrev_b32 v50, 16, v241
    v_and_b32 v51, s40, v241
    v_lshlrev_b32 v52, 16, v242
    v_and_b32 v53, s40, v242
    v_lshlrev_b32 v54, 16, v243
    v_and_b32 v55, s40, v243
    v_lshlrev_b32 v56, 16, v244
    v_and_b32 v57, s40, v244
    v_lshlrev_b32 v58, 16, v245
    v_and_b32 v59, s40, v245
    v_lshlrev_b32 v60, 16, v246
    v_and_b32 v61, s40, v246
    v_lshlrev_b32 v62, 16, v247
    v_and_b32 v63, s40, v247
    v_pk_add_f32 v[64:65], v[16:17], v[32:33] op_sel_hi:[1,0] neg_lo:[0,1] neg_hi:[0,1]
    v_pk_add_f32 v[66:67], v[18:19], v[32:33] op_sel_hi:[1,0] neg_lo:[0,1] neg_hi:[0,1]
    v_pk_add_f32 v[68:69], v[20:21], v[32:33] op_sel_hi:[1,0] neg_lo:[0,1] neg_hi:[0,1]
    v_pk_add_f32 v[70:71], v[22:23], v[32:33] op_sel_hi:[1,0] neg_lo:[0,1] neg_hi:[0,1]
    v_pk_add_f32 v[72:73], v[24:25], v[32:33] op_sel_hi:[1,0] neg_lo:[0,1] neg_hi:[0,1]
    v_pk_add_f32 v[74:75], v[26:27], v[32:33] op_sel_hi:[1,0] neg_lo:[0,1] neg_hi:[0,1]
    v_pk_add_f32 v[76:77], v[28:29], v[32:33] op_sel_hi:[1,0] neg_lo:[0,1] neg_hi:[0,1]
    v_pk_add_f32 v[78:79], v[30:31], v[32:33] op_sel_hi:[1,0] neg_lo:[0,1] neg_hi:[0,1]
    v_pk_mul_f32 v[64:65], v[64:65], v[32:33] op_sel:[0,1] op_sel_hi:[1,1]
    v_pk_mul_f32 v[66:67], v[66:67], v[32:33] op_sel:[0,1] op_sel_hi:[1,1]
    v_pk_mul_f32 v[68:69], v[68:69], v[32:33] op_sel:[0,1] op_sel_hi:[1,1]
    v_pk_mul_f32 v[70:71], v[70:71], v[32:33] op_sel:[0,1] op_sel_hi:[1,1]
    v_pk_mul_f32 v[72:73], v[72:73], v[32:33] op_sel:[0,1] op_sel_hi:[1,1]
    v_pk_mul_f32 v[74:75], v[74:75], v[32:33] op_sel:[0,1] op_sel_hi:[1,1]
    v_pk_mul_f32 v[76:77], v[76:77], v[32:33] op_sel:[0,1] op_sel_hi:[1,1]
    v_pk_mul_f32 v[78:79], v[78:79], v[32:33] op_sel:[0,1] op_sel_hi:[1,1]
    v_pk_fma_f32 v[64:65], v[64:65], v[48:49], v[16:17]
    v_pk_fma_f32 v[66:67], v[66:67], v[50:51], v[18:19]
    v_pk_fma_f32 v[68:69], v[68:69], v[52:53], v[20:21]
    v_pk_fma_f32 v[70:71], v[70:71], v[54:55], v[22:23]
    v_pk_fma_f32 v[72:73], v[72:73], v[56:57], v[24:25]
    v_pk_fma_f32 v[74:75], v[74:75], v[58:59], v[26:27]
    v_pk_fma_f32 v[76:77], v[76:77], v[60:61], v[28:29]
    v_pk_fma_f32 v[78:79], v[78:79], v[62:63], v[30:31]
    v_cvt_pk_bf16_f32 v232, v64, v65
    v_cvt_pk_bf16_f32 v233, v66, v67
    v_cvt_pk_bf16_f32 v234, v68, v69
    v_cvt_pk_bf16_f32 v235, v70, v71
    v_cvt_pk_bf16_f32 v236, v72, v73
    v_cvt_pk_bf16_f32 v237, v74, v75
    v_cvt_pk_bf16_f32 v238, v76, v77
    v_cvt_pk_bf16_f32 v239, v78, v79
    v_lshlrev_b32 v16, 16, v232
    v_and_b32 v17, s40, v232
    v_lshlrev_b32 v18, 16, v233
    v_and_b32 v19, s40, v233
    v_lshlrev_b32 v20, 16, v234
    v_and_b32 v21, s40, v234
    v_lshlrev_b32 v22, 16, v235
    v_and_b32 v23, s40, v235
    v_lshlrev_b32 v24, 16, v236
    v_and_b32 v25, s40, v236
    v_lshlrev_b32 v26, 16, v237
    v_and_b32 v27, s40, v237
    v_lshlrev_b32 v28, 16, v238
    v_and_b32 v29, s40, v238
    v_lshlrev_b32 v30, 16, v239
    v_and_b32 v31, s40, v239
    v_pk_add_f32 v[32:33], v[16:17], v[18:19]
    v_pk_mul_f32 v[34:35], v[16:17], v[16:17]
    v_pk_add_f32 v[36:37], v[20:21], v[22:23]
    v_pk_mul_f32 v[38:39], v[18:19], v[18:19]
    v_pk_fma_f32 v[34:35], v[20:21], v[20:21], v[34:35]
    v_pk_fma_f32 v[38:39], v[22:23], v[22:23], v[38:39]
    v_pk_fma_f32 v[34:35], v[24:25], v[24:25], v[34:35]
    v_pk_fma_f32 v[38:39], v[26:27], v[26:27], v[38:39]
    v_pk_add_f32 v[32:33], v[32:33], v[24:25]
    v_pk_add_f32 v[32:33], v[32:33], v[26:27]
    v_pk_fma_f32 v[34:35], v[28:29], v[28:29], v[34:35]
    v_pk_fma_f32 v[38:39], v[30:31], v[30:31], v[38:39]
    v_pk_add_f32 v[36:37], v[36:37], v[28:29]
    v_pk_add_f32 v[36:37], v[36:37], v[30:31]
    v_pk_add_f32 v[32:33], v[32:33], v[36:37]
    v_pk_add_f32 v[34:35], v[34:35], v[38:39]
    v_add_f32 v32, v32, v33
    v_add_f32 v33, v34, v35
    s_nop 0
    v_add_f32_dpp v32, v32, v32 row_ror:4 row_mask:0xf bank_mask:0xf
    v_add_f32_dpp v33, v33, v33 row_ror:4 row_mask:0xf bank_mask:0xf
    s_nop 0
    v_add_f32_dpp v32, v32, v32 row_ror:8 row_mask:0xf bank_mask:0xf
    v_add_f32_dpp v33, v33, v33 row_ror:8 row_mask:0xf bank_mask:0xf
    s_lshl_b32 s42, s38, 4
    s_add_u32 s42, s42, s39
    s_lshl_b32 s42, s42, 10
    s_add_u32 s42, s42, s44
    s_mov_b32 exec_lo, 0x000f000f
    s_mov_b32 exec_hi, 0x000f000f
    buffer_store_dwordx2 v[32:33], v5, s[28:31], s42 offen sc1
    s_mov_b64 exec, -1
    s_lshl_b32 s47, s70, 11
    s_add_u32 s47, s47, 102400
    v_lshrrev_b32 v8, 4, v2
    v_lshlrev_b32 v8, 2, v8
    v_and_b32 v9, 3, v2
    v_add_u32 v8, v8, v9
    v_lshlrev_b32 v8, 7, v8
    v_bfe_u32 v9, v2, 2, 2
    v_lshl_add_u32 v8, v9, 5, v8
    v_add_u32 v8, s47, v8
    ds_write_b64 v8, v[232:233] offset:0
    ds_write_b64 v8, v[234:235] offset:16
    ds_write_b64 v8, v[236:237] offset:8
    ds_write_b64 v8, v[238:239] offset:24
    v_lshl_add_u32 v9, v2, 4, s47
    s_lshl_b32 s45, s38, 3
    s_add_u32 s45, s45, s70
    s_lshl_b32 s45, s45, 15
    s_lshl_b32 s46, s39, 7
    s_add_u32 s45, s45, s46
    s_add_u32 s46, s45, 16384
    v_lshrrev_b32 v10, 3, v2
    v_lshlrev_b32 v10, 11, v10
    v_and_b32 v11, 7, v2
    v_lshl_add_u32 v10, v11, 4, v10
    s_waitcnt lgkmcnt(0)
    ds_read_b128 v[48:51], v9
    ds_read_b128 v[52:55], v9 offset:1024
    s_waitcnt lgkmcnt(1)
    buffer_store_dwordx4 v[48:51], v10, s[24:27], s45 offen sc1
    s_waitcnt lgkmcnt(0)
    buffer_store_dwordx4 v[52:55], v10, s[24:27], s46 offen sc1
    s_waitcnt vmcnt(0)
    s_barrier
    s_mul_i32 s36, s71, 98304
    s_lshl_b32 s37, s38, 11
    s_add_u32 s36, s36, s37
    s_lshl_b32 s37, s39, 7
    s_add_u32 s36, s36, s37
    s_add_u32 s36, s36, 65536
    s_cmp_eq_u32 s70, 0
    s_cbranch_scc0 L_interleave_layers__ssm_conv_h3__linear_hedgehog__prompt_sf_36
    v_mov_b32 v253, 0
    v_mov_b32 v254, s73
    s_mov_b64 exec, 1
    buffer_store_dword v254, v253, s[64:67], s36 offen sc1
    s_mov_b64 exec, -1
L_interleave_layers__ssm_conv_h3__linear_hedgehog__prompt_sf_36:
    s_lshl_b32 s36, s2, 7
    s_add_u32 s36, s36, 229376
    s_cmp_eq_u32 s70, 1
    s_cbranch_scc0 L_interleave_layers__ssm_conv_h3__linear_hedgehog__prompt_sf_37
    v_mov_b32 v253, 0
    v_mov_b32 v254, s73
    s_mov_b64 exec, 1
    buffer_store_dword v254, v253, s[64:67], s36 offen sc1
    s_mov_b64 exec, -1
L_interleave_layers__ssm_conv_h3__linear_hedgehog__prompt_sf_37:
    v_and_b32 v2, 63, v0
    s_and_b32 s36, s2, 7
    s_lshr_b32 s37, s2, 3
    s_mov_b32 s40, s70
    s_and_b32 s38, s36, 1
    s_lshl_b32 s38, s38, 2
    s_and_b32 s39, s37, 3
    s_add_u32 s38, s38, s39
    s_lshr_b32 s39, s36, 1
    s_lshl_b32 s39, s39, 3
    s_lshr_b32 s41, s37, 2
    s_add_u32 s39, s39, s41
    s_mul_i32 s14, s71, 0x2800000
    s_add_u32 s14, s14, 0xc00000
    s_add_u32 s12, s68, s14
    s_addc_u32 s13, s69, 0
    s_mov_b32 s14, 0x400000
    s_mov_b32 s15, 0x20000
    s_add_u32 s16, s68, 0x2000000
    s_addc_u32 s17, s69, 0
    s_mov_b32 s18, 0x600000
    s_mov_b32 s19, 0x20000
    s_mul_i32 s26, s71, 0x200000
    s_add_u32 s26, s26, 0x1c00000
    s_add_u32 s24, s68, s26
    s_addc_u32 s25, s69, 0
    s_mov_b32 s26, 0x200000
    s_mov_b32 s27, 0x20000
    s_mul_i32 s34, s71, 0x2800000
    s_add_u32 s34, s34, 0x1000000
    s_add_u32 s32, s68, s34
    s_addc_u32 s33, s69, 0
    s_mov_b32 s34, 0x400000
    s_mov_b32 s35, 0x20000
    v_and_b32 v3, 31, v2
    v_lshrrev_b32 v4, 5, v2
    v_lshlrev_b32 v5, 2, v4
    v_sub_u32 v3, v3, v5
    s_mov_b32 s45, 0x3f80
    v_subrev_u32 v5, 0, v3
    v_cmp_gt_u32 vcc, 2, v5
    v_lshlrev_b32 v6, 4, v5
    v_lshlrev_b32 v6, v6, s45
    v_cndmask_b32 v224, 0, v6, vcc
    v_subrev_u32 v5, 2, v3
    v_cmp_gt_u32 vcc, 2, v5
    v_lshlrev_b32 v6, 4, v5
    v_lshlrev_b32 v6, v6, s45
    v_cndmask_b32 v225, 0, v6, vcc
    v_subrev_u32 v5, 8, v3
    v_cmp_gt_u32 vcc, 2, v5
    v_lshlrev_b32 v6, 4, v5
    v_lshlrev_b32 v6, v6, s45
    v_cndmask_b32 v226, 0, v6, vcc
    v_subrev_u32 v5, 10, v3
    v_cmp_gt_u32 vcc, 2, v5
    v_lshlrev_b32 v6, 4, v5
    v_lshlrev_b32 v6, v6, s45
    v_cndmask_b32 v227, 0, v6, vcc
    v_subrev_u32 v5, 16, v3
    v_cmp_gt_u32 vcc, 2, v5
    v_lshlrev_b32 v6, 4, v5
    v_lshlrev_b32 v6, v6, s45
    v_cndmask_b32 v228, 0, v6, vcc
    v_subrev_u32 v5, 18, v3
    v_cmp_gt_u32 vcc, 2, v5
    v_lshlrev_b32 v6, 4, v5
    v_lshlrev_b32 v6, v6, s45
    v_cndmask_b32 v229, 0, v6, vcc
    v_subrev_u32 v5, 24, v3
    v_cmp_gt_u32 vcc, 2, v5
    v_lshlrev_b32 v6, 4, v5
    v_lshlrev_b32 v6, v6, s45
    v_cndmask_b32 v230, 0, v6, vcc
    v_subrev_u32 v5, 26, v3
    v_cmp_gt_u32 vcc, 2, v5
    v_lshlrev_b32 v6, 4, v5
    v_lshlrev_b32 v6, v6, s45
    v_cndmask_b32 v231, 0, v6, vcc
    s_cmp_ge_u32 s40, 4
    s_cbranch_scc1 L_interleave_layers__ssm_conv_h3__linear_hedgehog__prompt_prod_38
    v_and_b32 v3, 15, v2
    v_lshrrev_b32 v13, 4, v2
    v_lshrrev_b32 v5, 1, v3
    s_lshl_b32 s45, s40, 13
    v_lshlrev_b32 v6, 7, v3
    v_add_u32 v6, s45, v6
    v_add_u32 v7, 0, v13
    v_xor_b32 v7, v7, v5
    v_lshl_add_u32 v8, v7, 4, v6
    v_add_u32 v7, 4, v13
    v_xor_b32 v7, v7, v5
    v_lshl_add_u32 v9, v7, 4, v6
    v_lshrrev_b32 v5, 1, v13
    v_mul_u32_u24 v5, 3072, v5
    v_and_b32 v7, 1, v13
    v_lshlrev_b32 v7, 9, v7
    v_add_u32 v5, v5, v7
    v_lshl_add_u32 v5, v3, 4, v5
    v_add_u32 v12, 32768, v5
    s_mov_b32 s61, -90112
    s_mov_b32 s63, 45056
    s_mov_b32 s46, 0
    s_mov_b32 s47, 0
    s_barrier
    s_add_u32 s28, s68, 0x2a00000
    s_addc_u32 s29, s69, 0
    s_mov_b32 s30, 0x100000
    s_mov_b32 s31, 0x20000
    s_lshl_b32 s45, s71, 19
    s_add_u32 s45, s45, 262144
    s_lshl_b32 s48, s38, 1
    s_lshr_b32 s49, s40, 1
    s_add_u32 s48, s48, s49
    s_lshl_b32 s48, s48, 14
    s_add_u32 s45, s45, s48
    s_and_b32 s48, s40, 1
    s_lshl_b32 s48, s48, 9
    s_add_u32 s45, s45, s48
    v_lshlrev_b32 v3, 3, v2
    buffer_load_dwordx2 v[64:65], v3, s[28:31], s45 offen sc1
    s_add_u32 s45, s45, 1024
    buffer_load_dwordx2 v[66:67], v3, s[28:31], s45 offen sc1
    s_add_u32 s45, s45, 1024
    buffer_load_dwordx2 v[68:69], v3, s[28:31], s45 offen sc1
    s_add_u32 s45, s45, 1024
    buffer_load_dwordx2 v[70:71], v3, s[28:31], s45 offen sc1
    s_add_u32 s45, s45, 1024
    buffer_load_dwordx2 v[72:73], v3, s[28:31], s45 offen sc1
    s_add_u32 s45, s45, 1024
    buffer_load_dwordx2 v[74:75], v3, s[28:31], s45 offen sc1
    s_add_u32 s45, s45, 1024
    buffer_load_dwordx2 v[76:77], v3, s[28:31], s45 offen sc1
    s_add_u32 s45, s45, 1024
    buffer_load_dwordx2 v[78:79], v3, s[28:31], s45 offen sc1
    s_add_u32 s45, s45, 1024
    buffer_load_dwordx2 v[80:81], v3, s[28:31], s45 offen sc1
    s_add_u32 s45, s45, 1024
    buffer_load_dwordx2 v[82:83], v3, s[28:31], s45 offen sc1
    s_add_u32 s45, s45, 1024
    buffer_load_dwordx2 v[84:85], v3, s[28:31], s45 offen sc1
    s_add_u32 s45, s45, 1024
    buffer_load_dwordx2 v[86:87], v3, s[28:31], s45 offen sc1
    s_add_u32 s45, s45, 1024
    buffer_load_dwordx2 v[88:89], v3, s[28:31], s45 offen sc1
    s_add_u32 s45, s45, 1024
    buffer_load_dwordx2 v[90:91], v3, s[28:31], s45 offen sc1
    s_add_u32 s45, s45, 1024
    buffer_load_dwordx2 v[92:93], v3, s[28:31], s45 offen sc1
    s_add_u32 s45, s45, 1024
    buffer_load_dwordx2 v[94:95], v3, s[28:31], s45 offen sc1
    s_cmp_eq_u32 s71, 0
    s_cbranch_scc0 L_interleave_layers__ssm_conv_h3__linear_hedgehog__prompt_ncs_40
    s_cmp_lt_u32 s40, 3
    s_cbranch_scc0 L_interleave_layers__ssm_conv_h3__linear_hedgehog__prompt_ncs_40
    s_add_u32 s20, s68, 0x2b00000
    s_addc_u32 s21, s69, 0
    s_mov_b32 s22, 0x60000
    s_mov_b32 s23, 0x20000
    s_mul_i32 s45, s39, 12288
    s_lshl_b32 s48, s40, 7
    s_add_u32 s45, s45, s48
    v_and_b32 v3, 31, v2
    v_lshlrev_b32 v3, 2, v3
    v_lshrrev_b32 v5, 5, v2
    v_mul_u32_u24 v5, 6144, v5
    v_add_u32 v3, v3, v5
    buffer_load_dword v96, v3, s[20:23], s45 offen sc1
    s_add_u32 s45, s45, 384
    buffer_load_dword v97, v3, s[20:23], s45 offen sc1
    s_add_u32 s45, s45, 384
    buffer_load_dword v98, v3, s[20:23], s45 offen sc1
    s_add_u32 s45, s45, 384
    buffer_load_dword v99, v3, s[20:23], s45 offen sc1
    s_add_u32 s45, s45, 384
    buffer_load_dword v100, v3, s[20:23], s45 offen sc1
    s_add_u32 s45, s45, 384
    buffer_load_dword v101, v3, s[20:23], s45 offen sc1
    s_add_u32 s45, s45, 384
    buffer_load_dword v102, v3, s[20:23], s45 offen sc1
    s_add_u32 s45, s45, 384
    buffer_load_dword v103, v3, s[20:23], s45 offen sc1
    s_add_u32 s45, s45, 384
    buffer_load_dword v104, v3, s[20:23], s45 offen sc1
    s_add_u32 s45, s45, 384
    buffer_load_dword v105, v3, s[20:23], s45 offen sc1
    s_add_u32 s45, s45, 384
    buffer_load_dword v106, v3, s[20:23], s45 offen sc1
    s_add_u32 s45, s45, 384
    buffer_load_dword v107, v3, s[20:23], s45 offen sc1
    s_add_u32 s45, s45, 384
    buffer_load_dword v108, v3, s[20:23], s45 offen sc1
    s_add_u32 s45, s45, 384
    buffer_load_dword v109, v3, s[20:23], s45 offen sc1
    s_add_u32 s45, s45, 384
    buffer_load_dword v110, v3, s[20:23], s45 offen sc1
    s_add_u32 s45, s45, 384
    buffer_load_dword v111, v3, s[20:23], s45 offen sc1
    s_waitcnt vmcnt(0)
    v_add_f32 v96, v96, v104
    v_add_f32 v97, v97, v105
    v_add_f32 v98, v98, v106
    v_add_f32 v99, v99, v107
    v_add_f32 v100, v100, v108
    v_add_f32 v101, v101, v109
    v_add_f32 v102, v102, v110
    v_add_f32 v103, v103, v111
    v_add_f32 v96, v96, v100
    v_add_f32 v97, v97, v101
    v_add_f32 v98, v98, v102
    v_add_f32 v99, v99, v103
    v_add_f32 v96, v96, v98
    v_add_f32 v97, v97, v99
    v_add_f32 v96, v96, v97
    v_mov_b32 v97, v96
    s_nop 1
    v_permlane32_swap_b32 v96, v97
    v_add_f32 v96, v96, v97
    s_lshl_b32 s48, s40, 7
    s_add_u32 s48, s48, 137216
    v_and_b32 v3, 31, v2
    v_lshl_add_u32 v3, v3, 2, s48
    ds_write_b32 v3, v96
L_interleave_layers__ssm_conv_h3__linear_hedgehog__prompt_ncs_40:
    s_waitcnt vmcnt(0)
    v_pk_add_f32 v[64:65], v[64:65], v[80:81]
    v_pk_add_f32 v[66:67], v[66:67], v[82:83]
    v_pk_add_f32 v[68:69], v[68:69], v[84:85]
    v_pk_add_f32 v[70:71], v[70:71], v[86:87]
    v_pk_add_f32 v[72:73], v[72:73], v[88:89]
    v_pk_add_f32 v[74:75], v[74:75], v[90:91]
    v_pk_add_f32 v[76:77], v[76:77], v[92:93]
    v_pk_add_f32 v[78:79], v[78:79], v[94:95]
    v_pk_add_f32 v[64:65], v[64:65], v[72:73]
    v_pk_add_f32 v[66:67], v[66:67], v[74:75]
    v_pk_add_f32 v[68:69], v[68:69], v[76:77]
    v_pk_add_f32 v[70:71], v[70:71], v[78:79]
    v_pk_add_f32 v[64:65], v[64:65], v[68:69]
    v_pk_add_f32 v[66:67], v[66:67], v[70:71]
    v_pk_add_f32 v[64:65], v[64:65], v[66:67]
    v_mul_f32 v64, 0x3a800000, v64
    v_mul_f32 v65, 0x3a800000, v65
    v_fma_f32 v65, -v64, v64, v65
    v_max_f32 v65, 0, v65
    v_add_f32 v65, 0x3727c5ac, v65
    v_rsq_f32 v65, v65
    s_lshl_b32 s48, s40, 8
    s_add_u32 s48, s48, 135168
    v_lshl_add_u32 v3, v2, 2, s48
    ds_write_b32 v3, v64
    ds_write_b32 v3, v65 offset:1024
    v_mov_b32 v64, 0
    v_mov_b32 v65, 0
    v_mov_b32 v66, 0
    v_mov_b32 v67, 0
    v_mov_b32 v68, 0
    v_mov_b32 v69, 0
    v_mov_b32 v70, 0
    v_mov_b32 v71, 0
    v_mov_b32 v72, 0
    v_mov_b32 v73, 0
    v_mov_b32 v74, 0
    v_mov_b32 v75, 0
    v_mov_b32 v76, 0
    v_mov_b32 v77, 0
    v_mov_b32 v78, 0
    v_mov_b32 v79, 0
    v_mov_b32 v80, 0
    v_mov_b32 v81, 0
    v_mov_b32 v82, 0
    v_mov_b32 v83, 0
    v_mov_b32 v84, 0
    v_mov_b32 v85, 0
    v_mov_b32 v86, 0
    v_mov_b32 v87, 0
    v_mov_b32 v88, 0
    v_mov_b32 v89, 0
    v_mov_b32 v90, 0
    v_mov_b32 v91, 0
    v_mov_b32 v92, 0
    v_mov_b32 v93, 0
    v_mov_b32 v94, 0
    v_mov_b32 v95, 0
    v_mov_b32 v96, 0
    v_mov_b32 v97, 0
    v_mov_b32 v98, 0
    v_mov_b32 v99, 0
    v_mov_b32 v100, 0
    v_mov_b32 v101, 0
    v_mov_b32 v102, 0
    v_mov_b32 v103, 0
    v_mov_b32 v104, 0
    v_mov_b32 v105, 0
    v_mov_b32 v106, 0
    v_mov_b32 v107, 0
    v_mov_b32 v108, 0
    v_mov_b32 v109, 0
    v_mov_b32 v110, 0
    v_mov_b32 v111, 0
    v_mov_b32 v112, 0
    v_mov_b32 v113, 0
    v_mov_b32 v114, 0
    v_mov_b32 v115, 0
    v_mov_b32 v116, 0
    v_mov_b32 v117, 0
    v_mov_b32 v118, 0
    v_mov_b32 v119, 0
    v_mov_b32 v120, 0
    v_mov_b32 v121, 0
    v_mov_b32 v122, 0
    v_mov_b32 v123, 0
    v_mov_b32 v124, 0
    v_mov_b32 v125, 0
    v_mov_b32 v126, 0
    v_mov_b32 v127, 0
    v_mov_b32 v128, 0
    v_mov_b32 v129, 0
    v_mov_b32 v130, 0
    v_mov_b32 v131, 0
    v_mov_b32 v132, 0
    v_mov_b32 v133, 0
    v_mov_b32 v134, 0
    v_mov_b32 v135, 0
    v_mov_b32 v136, 0
    v_mov_b32 v137, 0
    v_mov_b32 v138, 0
    v_mov_b32 v139, 0
    v_mov_b32 v140, 0
    v_mov_b32 v141, 0
    v_mov_b32 v142, 0
    v_mov_b32 v143, 0
    v_mov_b32 v144, 0
    v_mov_b32 v145, 0
    v_mov_b32 v146, 0
    v_mov_b32 v147, 0
    v_mov_b32 v148, 0
    v_mov_b32 v149, 0
    v_mov_b32 v150, 0
    v_mov_b32 v151, 0
    v_mov_b32 v152, 0
    v_mov_b32 v153, 0
    v_mov_b32 v154, 0
    v_mov_b32 v155, 0
    v_mov_b32 v156, 0
    v_mov_b32 v157, 0
    v_mov_b32 v158, 0
    v_mov_b32 v159, 0
    s_waitcnt lgkmcnt(0)
    s_barrier
    ds_read_b128 v[16:19], v8 offset:0
    ds_read_b128 v[32:35], v12 offset:0
    ds_read_b128 v[36:39], v12 offset:256
    ds_read_b128 v[20:23], v8 offset:2048
    ds_read_b128 v[24:27], v8 offset:4096
    ds_read_b128 v[28:31], v8 offset:6144
    ds_read_b128 v[40:43], v12 offset:1024
    ds_read_b128 v[44:47], v12 offset:1280
    ds_read_b128 v[48:51], v12 offset:2048
    ds_read_b128 v[52:55], v12 offset:2304
L_interleave_layers__ssm_conv_h3__linear_hedgehog__prompt_cloop_41:
    s_waitcnt lgkmcnt(0)
    v_mfma_f32_16x16x32_bf16 v[64:67], v[32:35], v[16:19], v[64:67]
    ds_read_b128 v[160:163], v9 offset:0
    v_mfma_f32_16x16x32_bf16 v[72:75], v[36:39], v[16:19], v[72:75]
    ds_read_b128 v[176:179], v12 offset:6144
    v_mfma_f32_16x16x32_bf16 v[68:71], v[32:35], v[20:23], v[68:71]
    ds_read_b128 v[180:183], v12 offset:6400
    v_mfma_f32_16x16x32_bf16 v[76:79], v[36:39], v[20:23], v[76:79]
    ds_read_b128 v[164:167], v9 offset:2048
    v_mfma_f32_16x16x32_bf16 v[80:83], v[32:35], v[24:27], v[80:83]
    ds_read_b128 v[168:171], v9 offset:4096
    v_mfma_f32_16x16x32_bf16 v[88:91], v[36:39], v[24:27], v[88:91]
    ds_read_b128 v[172:175], v9 offset:6144
    v_mfma_f32_16x16x32_bf16 v[84:87], v[32:35], v[28:31], v[84:87]
    ds_read_b128 v[184:187], v12 offset:7168
    v_mfma_f32_16x16x32_bf16 v[92:95], v[36:39], v[28:31], v[92:95]
    ds_read_b128 v[188:191], v12 offset:7424
    v_mfma_f32_16x16x32_bf16 v[96:99], v[40:43], v[16:19], v[96:99]
    ds_read_b128 v[192:195], v12 offset:8192
    v_mfma_f32_16x16x32_bf16 v[104:107], v[44:47], v[16:19], v[104:107]
    ds_read_b128 v[196:199], v12 offset:8448
    v_mfma_f32_16x16x32_bf16 v[100:103], v[40:43], v[20:23], v[100:103]
    v_mfma_f32_16x16x32_bf16 v[108:111], v[44:47], v[20:23], v[108:111]
    v_mfma_f32_16x16x32_bf16 v[112:115], v[40:43], v[24:27], v[112:115]
    v_mfma_f32_16x16x32_bf16 v[120:123], v[44:47], v[24:27], v[120:123]
    v_mfma_f32_16x16x32_bf16 v[116:119], v[40:43], v[28:31], v[116:119]
    v_mfma_f32_16x16x32_bf16 v[124:127], v[44:47], v[28:31], v[124:127]
    v_mfma_f32_16x16x32_bf16 v[128:131], v[16:19], v[48:51], v[128:131]
    v_mfma_f32_16x16x32_bf16 v[132:135], v[16:19], v[52:55], v[132:135]
    v_mfma_f32_16x16x32_bf16 v[136:139], v[20:23], v[48:51], v[136:139]
    v_mfma_f32_16x16x32_bf16 v[140:143], v[20:23], v[52:55], v[140:143]
    v_mfma_f32_16x16x32_bf16 v[144:147], v[24:27], v[48:51], v[144:147]
    v_mfma_f32_16x16x32_bf16 v[148:151], v[24:27], v[52:55], v[148:151]
    v_mfma_f32_16x16x32_bf16 v[152:155], v[28:31], v[48:51], v[152:155]
    v_mfma_f32_16x16x32_bf16 v[156:159], v[28:31], v[52:55], v[156:159]
    s_add_u32 s47, s47, 1
    s_cmp_eq_u32 s47, 3
    s_cselect_b32 s48, s61, s63
    s_cselect_b32 s47, 0, s47
    v_add_u32 v8, s48, v8
    v_add_u32 v9, s48, v9
    v_add_u32 v12, s48, v12
    s_waitcnt lgkmcnt(0)
    s_barrier
    v_mfma_f32_16x16x32_bf16 v[64:67], v[176:179], v[160:163], v[64:67]
    ds_read_b128 v[16:19], v8 offset:0
    v_mfma_f32_16x16x32_bf16 v[72:75], v[180:183], v[160:163], v[72:75]
    ds_read_b128 v[32:35], v12 offset:0
    v_mfma_f32_16x16x32_bf16 v[68:71], v[176:179], v[164:167], v[68:71]
    ds_read_b128 v[36:39], v12 offset:256
    v_mfma_f32_16x16x32_bf16 v[76:79], v[180:183], v[164:167], v[76:79]
    ds_read_b128 v[20:23], v8 offset:2048
    v_mfma_f32_16x16x32_bf16 v[80:83], v[176:179], v[168:171], v[80:83]
    ds_read_b128 v[24:27], v8 offset:4096
    v_mfma_f32_16x16x32_bf16 v[88:91], v[180:183], v[168:171], v[88:91]
    ds_read_b128 v[28:31], v8 offset:6144
    v_mfma_f32_16x16x32_bf16 v[84:87], v[176:179], v[172:175], v[84:87]
    ds_read_b128 v[40:43], v12 offset:1024
    v_mfma_f32_16x16x32_bf16 v[92:95], v[180:183], v[172:175], v[92:95]
    ds_read_b128 v[44:47], v12 offset:1280
    v_mfma_f32_16x16x32_bf16 v[96:99], v[184:187], v[160:163], v[96:99]
    ds_read_b128 v[48:51], v12 offset:2048
    v_mfma_f32_16x16x32_bf16 v[104:107], v[188:191], v[160:163], v[104:107]
    ds_read_b128 v[52:55], v12 offset:2304
    v_mfma_f32_16x16x32_bf16 v[100:103], v[184:187], v[164:167], v[100:103]
    v_mfma_f32_16x16x32_bf16 v[108:111], v[188:191], v[164:167], v[108:111]
    v_mfma_f32_16x16x32_bf16 v[112:115], v[184:187], v[168:171], v[112:115]
    v_mfma_f32_16x16x32_bf16 v[120:123], v[188:191], v[168:171], v[120:123]
    v_mfma_f32_16x16x32_bf16 v[116:119], v[184:187], v[172:175], v[116:119]
    v_mfma_f32_16x16x32_bf16 v[124:127], v[188:191], v[172:175], v[124:127]
    v_mfma_f32_16x16x32_bf16 v[128:131], v[160:163], v[192:195], v[128:131]
    v_mfma_f32_16x16x32_bf16 v[132:135], v[160:163], v[196:199], v[132:135]
    v_mfma_f32_16x16x32_bf16 v[136:139], v[164:167], v[192:195], v[136:139]
    v_mfma_f32_16x16x32_bf16 v[140:143], v[164:167], v[196:199], v[140:143]
    v_mfma_f32_16x16x32_bf16 v[144:147], v[168:171], v[192:195], v[144:147]
    v_mfma_f32_16x16x32_bf16 v[148:151], v[168:171], v[196:199], v[148:151]
    v_mfma_f32_16x16x32_bf16 v[152:155], v[172:175], v[192:195], v[152:155]
    s_add_u32 s46, s46, 1
    s_cmp_lt_u32 s46, 16
    v_mfma_f32_16x16x32_bf16 v[156:159], v[172:175], v[196:199], v[156:159]
    s_cbranch_scc1 L_interleave_layers__ssm_conv_h3__linear_hedgehog__prompt_cloop_41
    s_waitcnt lgkmcnt(0)
    s_mul_i32 s45, s40, 12288
    v_lshl_add_u32 v3, v2, 4, s45
    ds_write_b128 v3, v[112:115] offset:0
    ds_write_b128 v3, v[116:119] offset:1024
    ds_write_b128 v3, v[120:123] offset:2048
    ds_write_b128 v3, v[124:127] offset:3072
    ds_write_b128 v3, v[144:147] offset:8192
    ds_write_b128 v3, v[148:151] offset:9216
    ds_write_b128 v3, v[152:155] offset:10240
    ds_write_b128 v3, v[156:159] offset:11264
    s_lshl_b32 s43, s40, 1
    s_waitcnt lgkmcnt(0)
    s_barrier
    s_lshl_b32 s45, s40, 12
    s_add_u32 s45, s45, 143360
    v_lshl_add_u32 v3, v2, 4, s45
    ds_write_b128 v3, v[80:83] offset:0
    ds_write_b128 v3, v[84:87] offset:1024
    ds_write_b128 v3, v[88:91] offset:2048
    ds_write_b128 v3, v[92:95] offset:3072
    s_branch L_interleave_layers__ssm_conv_h3__linear_hedgehog__prompt_epi_39
L_interleave_layers__ssm_conv_h3__linear_hedgehog__prompt_prod_38:
    s_sub_u32 s43, s40, 4
    v_lshrrev_b32 v3, 3, v2
    v_and_b32 v4, 7, v2
    v_lshrrev_b32 v5, 4, v2
    s_lshl_b32 s45, s38, 8
    s_lshl_b32 s46, s43, 6
    s_add_u32 s45, s45, s46
    v_add_u32 v6, s45, v3
    v_lshlrev_b32 v6, 11, v6
    v_xor_b32 v7, v4, v5
    v_lshl_add_u32 v8, v7, 4, v6
    v_xor_b32 v7, 4, v7
    v_lshl_add_u32 v9, v7, 4, v6
    v_add_u32 v9, 15360, v9
    v_add_u32 v10, 30720, v8
    v_add_u32 v11, 30720, v9
    v_lshlrev_b32 v12, 4, v2
    s_lshl_b32 s50, s43, 13
    s_mul_i32 s51, s43, 3072
    s_add_u32 s51, s51, 32768
    s_mul_i32 s54, s39, 196608
    s_mul_i32 s45, s43, 3072
    s_add_u32 s54, s54, s45
    s_mul_i32 s45, s71, 98304
    s_lshl_b32 s46, s38, 12
    s_add_u32 s45, s45, s46
    s_add_u32 s45, s45, 65536
    s_cmp_eq_u32 s70, 4
    s_cbranch_scc0 L_interleave_layers__ssm_conv_h3__linear_hedgehog__prompt_np_42
    v_and_b32 v253, 63, v0
    v_lshlrev_b32 v253, 7, v253
    s_mov_b32 exec_lo, 0xffffffff
    s_mov_b32 exec_hi, 0
    s_mov_b32 s62, 0
L_interleave_layers__ssm_conv_h3__linear_hedgehog__prompt_pl_43:
    buffer_load_dword v248, v253, s[64:67], s45 offen sc1
    s_waitcnt vmcnt(0)
    v_cmp_eq_u32 vcc, s73, v248
    s_nop 3
    s_cmp_eq_u64 vcc, exec
    s_cbranch_scc1 L_interleave_layers__ssm_conv_h3__linear_hedgehog__prompt_pd_44
    s_sleep 1
    s_add_u32 s62, s62, 1
    s_cmp_lt_u32 s62, 0x10000
    s_cbranch_scc1 L_interleave_layers__ssm_conv_h3__linear_hedgehog__prompt_pl_43
L_interleave_layers__ssm_conv_h3__linear_hedgehog__prompt_pd_44:
    s_mov_b64 exec, -1
L_interleave_layers__ssm_conv_h3__linear_hedgehog__prompt_np_42:
    s_lshr_b32 s45, s39, 2
    s_lshl_b32 s45, s45, 7
    s_add_u32 s45, s45, 229376
    s_cmp_eq_u32 s70, 5
    s_cbranch_scc0 L_interleave_layers__ssm_conv_h3__linear_hedgehog__prompt_np_45
    v_and_b32 v253, 63, v0
    v_lshlrev_b32 v253, 10, v253
    s_mov_b32 exec_lo, 0xffffffff
    s_mov_b32 exec_hi, 0
    s_mov_b32 s62, 0
L_interleave_layers__ssm_conv_h3__linear_hedgehog__prompt_pl_46:
    buffer_load_dword v248, v253, s[64:67], s45 offen sc1
    s_waitcnt vmcnt(0)
    v_cmp_eq_u32 vcc, s73, v248
    s_nop 3
    s_cmp_eq_u64 vcc, exec
    s_cbranch_scc1 L_interleave_layers__ssm_conv_h3__linear_hedgehog__prompt_pd_47
    s_sleep 1
    s_add_u32 s62, s62, 1
    s_cmp_lt_u32 s62, 0x10000
    s_cbranch_scc1 L_interleave_layers__ssm_conv_h3__linear_hedgehog__prompt_pl_46
L_interleave_layers__ssm_conv_h3__linear_hedgehog__prompt_pd_47:
    s_mov_b64 exec, -1
L_interleave_layers__ssm_conv_h3__linear_hedgehog__prompt_np_45:
    s_and_b32 s45, s2, 7
    s_lshr_b32 s45, s45, 2
    s_lshl_b32 s45, s45, 3
    s_lshr_b32 s46, s2, 5
    s_add_u32 s45, s45, s46
    s_lshr_b32 s45, s45, 1
    s_lshl_b32 s45, s45, 7
    s_add_u32 s45, s45, 229376
    s_cmp_eq_u32 s70, 6
    s_cbranch_scc0 L_interleave_layers__ssm_conv_h3__linear_hedgehog__prompt_np_48
    v_and_b32 v253, 63, v0
    v_lshlrev_b32 v253, 10, v253
    s_mov_b32 exec_lo, 0xffffffff
    s_mov_b32 exec_hi, 0
    s_mov_b32 s62, 0
L_interleave_layers__ssm_conv_h3__linear_hedgehog__prompt_pl_49:
    buffer_load_dword v248, v253, s[64:67], s45 offen sc1
    s_waitcnt vmcnt(0)
    v_cmp_eq_u32 vcc, s73, v248
    s_nop 3
    s_cmp_eq_u64 vcc, exec
    s_cbranch_scc1 L_interleave_layers__ssm_conv_h3__linear_hedgehog__prompt_pd_50
    s_sleep 1
    s_add_u32 s62, s62, 1
    s_cmp_lt_u32 s62, 0x10000
    s_cbranch_scc1 L_interleave_layers__ssm_conv_h3__linear_hedgehog__prompt_pl_49
L_interleave_layers__ssm_conv_h3__linear_hedgehog__prompt_pd_50:
    s_mov_b64 exec, -1
L_interleave_layers__ssm_conv_h3__linear_hedgehog__prompt_np_48:
    s_barrier
    s_mov_b32 s52, 0
    s_mov_b32 s53, 0
    s_add_u32 s55, s52, s50
    s_add_u32 s56, s53, 65536
    s_mov_b32 m0, s55
    s_nop 0
    buffer_load_dwordx4 v8, s[12:15], s53 offen offset:0 sc1 lds
    buffer_load_dwordx4 v9, s[12:15], s53 offen offset:1024 sc1 lds
    buffer_load_dwordx4 v10, s[12:15], s53 offen offset:2048 sc1 lds
    buffer_load_dwordx4 v11, s[12:15], s53 offen offset:3072 sc1 lds
    s_add_u32 s55, s55, 4096
    s_mov_b32 m0, s55
    s_nop 0
    buffer_load_dwordx4 v8, s[12:15], s56 offen offset:0 sc1 lds
    buffer_load_dwordx4 v9, s[12:15], s56 offen offset:1024 sc1 lds
    buffer_load_dwordx4 v10, s[12:15], s56 offen offset:2048 sc1 lds
    buffer_load_dwordx4 v11, s[12:15], s56 offen offset:3072 sc1 lds
    s_add_u32 s55, s52, s51
    s_mov_b32 m0, s55
    s_nop 0
    buffer_load_dwordx4 v12, s[16:19], s54 offen offset:0 sc1 lds
    buffer_load_dwordx4 v12, s[16:19], s54 offen offset:1024 sc1 lds
    buffer_load_dwordx4 v12, s[16:19], s54 offen offset:2048 sc1 lds
    s_add_u32 s54, s54, 12288
    s_add_u32 s53, s53, 128
    s_add_u32 s52, s52, 45056
    s_cmp_eq_u32 s52, 135168
    s_cselect_b32 s52, 0, s52
    s_add_u32 s55, s52, s50
    s_add_u32 s56, s53, 65536
    s_mov_b32 m0, s55
    s_nop 0
    buffer_load_dwordx4 v8, s[12:15], s53 offen offset:0 sc1 lds
    buffer_load_dwordx4 v9, s[12:15], s53 offen offset:1024 sc1 lds
    buffer_load_dwordx4 v10, s[12:15], s53 offen offset:2048 sc1 lds
    buffer_load_dwordx4 v11, s[12:15], s53 offen offset:3072 sc1 lds
    s_add_u32 s55, s55, 4096
    s_mov_b32 m0, s55
    s_nop 0
    buffer_load_dwordx4 v8, s[12:15], s56 offen offset:0 sc1 lds
    buffer_load_dwordx4 v9, s[12:15], s56 offen offset:1024 sc1 lds
    buffer_load_dwordx4 v10, s[12:15], s56 offen offset:2048 sc1 lds
    buffer_load_dwordx4 v11, s[12:15], s56 offen offset:3072 sc1 lds
    s_add_u32 s55, s52, s51
    s_mov_b32 m0, s55
    s_nop 0
    buffer_load_dwordx4 v12, s[16:19], s54 offen offset:0 sc1 lds
    buffer_load_dwordx4 v12, s[16:19], s54 offen offset:1024 sc1 lds
    buffer_load_dwordx4 v12, s[16:19], s54 offen offset:2048 sc1 lds
    s_add_u32 s54, s54, 12288
    s_add_u32 s53, s53, 128
    s_add_u32 s52, s52, 45056
    s_cmp_eq_u32 s52, 135168
    s_cselect_b32 s52, 0, s52
    s_waitcnt vmcnt(11)
    s_barrier
    s_add_u32 s55, s52, s50
    s_add_u32 s56, s53, 65536
    s_mov_b32 m0, s55
    s_nop 0
    buffer_load_dwordx4 v8, s[12:15], s53 offen offset:0 sc1 lds
    buffer_load_dwordx4 v9, s[12:15], s53 offen offset:1024 sc1 lds
    buffer_load_dwordx4 v10, s[12:15], s53 offen offset:2048 sc1 lds
    buffer_load_dwordx4 v11, s[12:15], s53 offen offset:3072 sc1 lds
    s_add_u32 s55, s55, 4096
    s_mov_b32 m0, s55
    s_nop 0
    buffer_load_dwordx4 v8, s[12:15], s56 offen offset:0 sc1 lds
    buffer_load_dwordx4 v9, s[12:15], s56 offen offset:1024 sc1 lds
    buffer_load_dwordx4 v10, s[12:15], s56 offen offset:2048 sc1 lds
    buffer_load_dwordx4 v11, s[12:15], s56 offen offset:3072 sc1 lds
    s_add_u32 s55, s52, s51
    s_mov_b32 m0, s55
    s_nop 0
    buffer_load_dwordx4 v12, s[16:19], s54 offen offset:0 sc1 lds
    buffer_load_dwordx4 v12, s[16:19], s54 offen offset:1024 sc1 lds
    buffer_load_dwordx4 v12, s[16:19], s54 offen offset:2048 sc1 lds
    s_add_u32 s54, s54, 12288
    s_add_u32 s53, s53, 128
    s_add_u32 s52, s52, 45056
    s_cmp_eq_u32 s52, 135168
    s_cselect_b32 s52, 0, s52
    s_mov_b32 s46, 1
L_interleave_layers__ssm_conv_h3__linear_hedgehog__prompt_ploop_51:
    s_waitcnt vmcnt(11)
    s_barrier
    s_add_u32 s55, s52, s50
    s_add_u32 s56, s53, 65536
    s_mov_b32 m0, s55
    s_nop 0
    buffer_load_dwordx4 v8, s[12:15], s53 offen offset:0 sc1 lds
    buffer_load_dwordx4 v9, s[12:15], s53 offen offset:1024 sc1 lds
    buffer_load_dwordx4 v10, s[12:15], s53 offen offset:2048 sc1 lds
    buffer_load_dwordx4 v11, s[12:15], s53 offen offset:3072 sc1 lds
    s_add_u32 s55, s55, 4096
    s_mov_b32 m0, s55
    s_nop 0
    buffer_load_dwordx4 v8, s[12:15], s56 offen offset:0 sc1 lds
    buffer_load_dwordx4 v9, s[12:15], s56 offen offset:1024 sc1 lds
    buffer_load_dwordx4 v10, s[12:15], s56 offen offset:2048 sc1 lds
    buffer_load_dwordx4 v11, s[12:15], s56 offen offset:3072 sc1 lds
    s_add_u32 s55, s52, s51
    s_mov_b32 m0, s55
    s_nop 0
    buffer_load_dwordx4 v12, s[16:19], s54 offen offset:0 sc1 lds
    buffer_load_dwordx4 v12, s[16:19], s54 offen offset:1024 sc1 lds
    buffer_load_dwordx4 v12, s[16:19], s54 offen offset:2048 sc1 lds
    s_add_u32 s54, s54, 12288
    s_add_u32 s53, s53, 128
    s_add_u32 s52, s52, 45056
    s_cmp_eq_u32 s52, 135168
    s_cselect_b32 s52, 0, s52
    s_add_u32 s46, s46, 1
    s_cmp_lt_u32 s46, 14
    s_cbranch_scc1 L_interleave_layers__ssm_conv_h3__linear_hedgehog__prompt_ploop_51
    s_waitcnt vmcnt(11)
    s_barrier
    s_waitcnt vmcnt(0)
    s_barrier
    s_barrier
    s_mul_i32 s45, s43, 12288
    v_lshl_add_u32 v3, v2, 4, s45
    s_lshl_b32 s43, s43, 1
    s_add_u32 s43, s43, 1
    s_barrier
    ds_read_b128 v[96:99], v3 offset:0
    ds_read_b128 v[100:103], v3 offset:1024
    ds_read_b128 v[104:107], v3 offset:2048
    ds_read_b128 v[108:111], v3 offset:3072
    ds_read_b128 v[128:131], v3 offset:8192
    ds_read_b128 v[132:135], v3 offset:9216
    ds_read_b128 v[136:139], v3 offset:10240
    ds_read_b128 v[140:143], v3 offset:11264
    s_sub_u32 s45, s40, 4
    s_lshl_b32 s45, s45, 12
    s_add_u32 s45, s45, 143360
    v_lshl_add_u32 v55, v2, 4, s45
L_interleave_layers__ssm_conv_h3__linear_hedgehog__prompt_epi_39:
    v_and_b32 v3, 31, v2
    v_lshrrev_b32 v4, 5, v2
    s_lshl_b32 s45, s43, 7
    s_add_u32 s45, s45, 135168
    v_lshl_add_u32 v5, v3, 2, s45
    ds_read_b32 v52, v5
    ds_read_b32 v53, v5 offset:1024
    v_lshl_add_u32 v5, v4, 4, s45
    ds_read_b128 v[160:163], v5 offset:0
    ds_read_b128 v[164:167], v5 offset:32
    ds_read_b128 v[168:171], v5 offset:64
    ds_read_b128 v[172:175], v5 offset:96
    ds_read_b128 v[176:179], v5 offset:1024
    ds_read_b128 v[180:183], v5 offset:1056
    ds_read_b128 v[184:187], v5 offset:1088
    ds_read_b128 v[188:191], v5 offset:1120
    s_mov_b32 s45, 137216
    v_lshl_add_u32 v5, v4, 4, s45
    ds_read_b128 v[32:35], v5 offset:128
    ds_read_b128 v[36:39], v5 offset:160
    ds_read_b128 v[40:43], v5 offset:192
    ds_read_b128 v[44:47], v5 offset:224
    ds_read_b128 v[16:19], v5 offset:0
    ds_read_b128 v[20:23], v5 offset:32
    ds_read_b128 v[24:27], v5 offset:64
    ds_read_b128 v[28:31], v5 offset:96
    v_lshl_add_u32 v5, v3, 2, s45
    ds_read_b32 v54, v5 offset:256
    s_mov_b32 s60, 0
    s_waitcnt lgkmcnt(0)
    v_permlane16_swap_b32 v96, v100
    v_permlane16_swap_b32 v97, v101
    v_permlane16_swap_b32 v98, v102
    v_permlane16_swap_b32 v99, v103
    v_permlane16_swap_b32 v104, v108
    v_permlane16_swap_b32 v105, v109
    v_permlane16_swap_b32 v106, v110
    v_permlane16_swap_b32 v107, v111
    v_permlane32_swap_b32 v96, v100
    v_permlane32_swap_b32 v97, v101
    v_permlane32_swap_b32 v98, v102
    v_permlane32_swap_b32 v99, v103
    v_permlane32_swap_b32 v104, v108
    v_permlane32_swap_b32 v105, v109
    v_permlane32_swap_b32 v106, v110
    v_permlane32_swap_b32 v107, v111
    v_permlane16_swap_b32 v128, v132
    v_permlane16_swap_b32 v129, v133
    v_permlane16_swap_b32 v130, v134
    v_permlane16_swap_b32 v131, v135
    v_permlane16_swap_b32 v136, v140
    v_permlane16_swap_b32 v137, v141
    v_permlane16_swap_b32 v138, v142
    v_permlane16_swap_b32 v139, v143
    v_permlane32_swap_b32 v128, v132
    v_permlane32_swap_b32 v129, v133
    v_permlane32_swap_b32 v130, v134
    v_permlane32_swap_b32 v131, v135
    v_permlane32_swap_b32 v136, v140
    v_permlane32_swap_b32 v137, v141
    v_permlane32_swap_b32 v138, v142
    v_permlane32_swap_b32 v139, v143
    v_mul_f32 v14, 0x3fb8aa3b, v53
    v_pk_fma_f32 v[96:97], v[32:33], v[52:53], v[96:97] op_sel_hi:[1,0,1] neg_lo:[0,1,0] neg_hi:[0,1,0]
    v_pk_fma_f32 v[98:99], v[34:35], v[52:53], v[98:99] op_sel_hi:[1,0,1] neg_lo:[0,1,0] neg_hi:[0,1,0]
    v_pk_fma_f32 v[100:101], v[36:37], v[52:53], v[100:101] op_sel_hi:[1,0,1] neg_lo:[0,1,0] neg_hi:[0,1,0]
    v_pk_fma_f32 v[102:103], v[38:39], v[52:53], v[102:103] op_sel_hi:[1,0,1] neg_lo:[0,1,0] neg_hi:[0,1,0]
    v_pk_fma_f32 v[104:105], v[40:41], v[52:53], v[104:105] op_sel_hi:[1,0,1] neg_lo:[0,1,0] neg_hi:[0,1,0]
    v_pk_fma_f32 v[106:107], v[42:43], v[52:53], v[106:107] op_sel_hi:[1,0,1] neg_lo:[0,1,0] neg_hi:[0,1,0]
    v_pk_fma_f32 v[108:109], v[44:45], v[52:53], v[108:109] op_sel_hi:[1,0,1] neg_lo:[0,1,0] neg_hi:[0,1,0]
    v_pk_fma_f32 v[110:111], v[46:47], v[52:53], v[110:111] op_sel_hi:[1,0,1] neg_lo:[0,1,0] neg_hi:[0,1,0]
    v_pk_fma_f32 v[128:129], v[160:161], v[54:55], v[128:129] op_sel_hi:[1,0,1] neg_lo:[0,1,0] neg_hi:[0,1,0]
    v_pk_fma_f32 v[130:131], v[162:163], v[54:55], v[130:131] op_sel_hi:[1,0,1] neg_lo:[0,1,0] neg_hi:[0,1,0]
    v_pk_fma_f32 v[132:133], v[164:165], v[54:55], v[132:133] op_sel_hi:[1,0,1] neg_lo:[0,1,0] neg_hi:[0,1,0]
    v_pk_fma_f32 v[134:135], v[166:167], v[54:55], v[134:135] op_sel_hi:[1,0,1] neg_lo:[0,1,0] neg_hi:[0,1,0]
    v_pk_fma_f32 v[136:137], v[168:169], v[54:55], v[136:137] op_sel_hi:[1,0,1] neg_lo:[0,1,0] neg_hi:[0,1,0]
    v_pk_fma_f32 v[138:139], v[170:171], v[54:55], v[138:139] op_sel_hi:[1,0,1] neg_lo:[0,1,0] neg_hi:[0,1,0]
    v_pk_fma_f32 v[140:141], v[172:173], v[54:55], v[140:141] op_sel_hi:[1,0,1] neg_lo:[0,1,0] neg_hi:[0,1,0]
    v_pk_fma_f32 v[142:143], v[174:175], v[54:55], v[142:143] op_sel_hi:[1,0,1] neg_lo:[0,1,0] neg_hi:[0,1,0]
    v_pk_mul_f32 v[128:129], v[128:129], v[176:177]
    v_pk_mul_f32 v[130:131], v[130:131], v[178:179]
    v_pk_mul_f32 v[132:133], v[132:133], v[180:181]
    v_pk_mul_f32 v[134:135], v[134:135], v[182:183]
    v_pk_mul_f32 v[136:137], v[136:137], v[184:185]
    v_pk_mul_f32 v[138:139], v[138:139], v[186:187]
    v_pk_mul_f32 v[140:141], v[140:141], v[188:189]
    v_pk_mul_f32 v[142:143], v[142:143], v[190:191]
    v_cvt_pk_bf16_f32 v208, v128, v129
    v_cvt_pk_bf16_f32 v209, v130, v131
    v_cvt_pk_bf16_f32 v210, v132, v133
    v_cvt_pk_bf16_f32 v211, v134, v135
    v_cvt_pk_bf16_f32 v212, v136, v137
    v_cvt_pk_bf16_f32 v213, v138, v139
    v_cvt_pk_bf16_f32 v214, v140, v141
    v_cvt_pk_bf16_f32 v215, v142, v143
L_interleave_layers__ssm_conv_h3__linear_hedgehog__prompt_sm_52:
    v_max3_f32 v8, v96, v97, v98
    v_min3_f32 v9, v96, v97, v98
    v_max3_f32 v10, v99, v100, v101
    v_min3_f32 v11, v99, v100, v101
    v_max3_f32 v8, v8, v102, v103
    v_min3_f32 v9, v9, v102, v103
    v_max3_f32 v10, v10, v104, v105
    v_min3_f32 v11, v11, v104, v105
    v_max3_f32 v8, v8, v106, v107
    v_min3_f32 v9, v9, v106, v107
    v_max3_f32 v10, v10, v108, v109
    v_min3_f32 v11, v11, v108, v109
    v_max3_f32 v8, v8, v110, v111
    v_min3_f32 v9, v9, v110, v111
    v_max_f32 v8, v8, v10
    v_min_f32 v9, v9, v11
    v_mul_f32 v8, -v8, v14
    v_mul_f32 v9, v9, v14
    s_nop 1
    v_permlane32_swap_b32 v8, v9
    v_min_f32 v8, v8, v9
    v_mov_b32 v9, v8
    s_nop 1
    v_permlane32_swap_b32 v8, v9
    v_pk_fma_f32 v[112:113], v[96:97], v[14:15], v[8:9] op_sel_hi:[1,0,0]
    v_pk_fma_f32 v[96:97], v[96:97], v[14:15], v[8:9] op_sel:[0,0,1] op_sel_hi:[1,0,1] neg_lo:[1,0,0] neg_hi:[1,0,0]
    v_pk_fma_f32 v[114:115], v[98:99], v[14:15], v[8:9] op_sel_hi:[1,0,0]
    v_pk_fma_f32 v[98:99], v[98:99], v[14:15], v[8:9] op_sel:[0,0,1] op_sel_hi:[1,0,1] neg_lo:[1,0,0] neg_hi:[1,0,0]
    v_pk_fma_f32 v[116:117], v[100:101], v[14:15], v[8:9] op_sel_hi:[1,0,0]
    v_pk_fma_f32 v[100:101], v[100:101], v[14:15], v[8:9] op_sel:[0,0,1] op_sel_hi:[1,0,1] neg_lo:[1,0,0] neg_hi:[1,0,0]
    v_pk_fma_f32 v[118:119], v[102:103], v[14:15], v[8:9] op_sel_hi:[1,0,0]
    v_pk_fma_f32 v[102:103], v[102:103], v[14:15], v[8:9] op_sel:[0,0,1] op_sel_hi:[1,0,1] neg_lo:[1,0,0] neg_hi:[1,0,0]
    v_pk_fma_f32 v[120:121], v[104:105], v[14:15], v[8:9] op_sel_hi:[1,0,0]
    v_pk_fma_f32 v[104:105], v[104:105], v[14:15], v[8:9] op_sel:[0,0,1] op_sel_hi:[1,0,1] neg_lo:[1,0,0] neg_hi:[1,0,0]
    v_pk_fma_f32 v[122:123], v[106:107], v[14:15], v[8:9] op_sel_hi:[1,0,0]
    v_pk_fma_f32 v[106:107], v[106:107], v[14:15], v[8:9] op_sel:[0,0,1] op_sel_hi:[1,0,1] neg_lo:[1,0,0] neg_hi:[1,0,0]
    v_pk_fma_f32 v[124:125], v[108:109], v[14:15], v[8:9] op_sel_hi:[1,0,0]
    v_pk_fma_f32 v[108:109], v[108:109], v[14:15], v[8:9] op_sel:[0,0,1] op_sel_hi:[1,0,1] neg_lo:[1,0,0] neg_hi:[1,0,0]
    v_pk_fma_f32 v[126:127], v[110:111], v[14:15], v[8:9] op_sel_hi:[1,0,0]
    v_pk_fma_f32 v[110:111], v[110:111], v[14:15], v[8:9] op_sel:[0,0,1] op_sel_hi:[1,0,1] neg_lo:[1,0,0] neg_hi:[1,0,0]
    v_exp_f32 v112, v112
    v_exp_f32 v96, v96
    v_exp_f32 v113, v113
    v_exp_f32 v97, v97
    v_exp_f32 v114, v114
    v_exp_f32 v98, v98
    v_exp_f32 v115, v115
    v_exp_f32 v99, v99
    v_exp_f32 v116, v116
    v_exp_f32 v100, v100
    v_exp_f32 v117, v117
    v_exp_f32 v101, v101
    v_exp_f32 v118, v118
    v_exp_f32 v102, v102
    v_exp_f32 v119, v119
    v_exp_f32 v103, v103
    v_exp_f32 v120, v120
    v_exp_f32 v104, v104
    v_exp_f32 v121, v121
    v_exp_f32 v105, v105
    v_exp_f32 v122, v122
    v_exp_f32 v106, v106
    v_exp_f32 v123, v123
    v_exp_f32 v107, v107
    v_exp_f32 v124, v124
    v_exp_f32 v108, v108
    v_exp_f32 v125, v125
    v_exp_f32 v109, v109
    v_exp_f32 v126, v126
    v_exp_f32 v110, v110
    v_exp_f32 v127, v127
    v_exp_f32 v111, v111
    v_pk_add_f32 v[10:11], v[112:113], v[114:115]
    v_pk_add_f32 v[12:13], v[96:97], v[98:99]
    v_pk_add_f32 v[10:11], v[10:11], v[116:117]
    v_pk_add_f32 v[12:13], v[12:13], v[100:101]
    v_pk_add_f32 v[10:11], v[10:11], v[118:119]
    v_pk_add_f32 v[12:13], v[12:13], v[102:103]
    v_pk_add_f32 v[10:11], v[10:11], v[120:121]
    v_pk_add_f32 v[12:13], v[12:13], v[104:105]
    v_pk_add_f32 v[10:11], v[10:11], v[122:123]
    v_pk_add_f32 v[12:13], v[12:13], v[106:107]
    v_pk_add_f32 v[10:11], v[10:11], v[124:125]
    v_pk_add_f32 v[12:13], v[12:13], v[108:109]
    v_pk_add_f32 v[10:11], v[10:11], v[126:127]
    v_pk_add_f32 v[12:13], v[12:13], v[110:111]
    v_add_f32 v10, v10, v11
    v_add_f32 v12, v12, v13
    s_nop 1
    v_permlane32_swap_b32 v10, v12
    v_add_f32 v10, v10, v12
    v_rcp_f32 v10, v10
    s_nop 0
    v_mov_b32 v11, v10
    s_nop 1
    v_permlane32_swap_b32 v10, v11
    v_pk_mul_f32 v[112:113], v[112:113], v[10:11] op_sel_hi:[1,0]
    v_pk_mul_f32 v[96:97], v[96:97], v[10:11] op_sel:[0,1] op_sel_hi:[1,1]
    v_pk_mul_f32 v[114:115], v[114:115], v[10:11] op_sel_hi:[1,0]
    v_pk_mul_f32 v[98:99], v[98:99], v[10:11] op_sel:[0,1] op_sel_hi:[1,1]
    v_pk_mul_f32 v[116:117], v[116:117], v[10:11] op_sel_hi:[1,0]
    v_pk_mul_f32 v[100:101], v[100:101], v[10:11] op_sel:[0,1] op_sel_hi:[1,1]
    v_pk_mul_f32 v[118:119], v[118:119], v[10:11] op_sel_hi:[1,0]
    v_pk_mul_f32 v[102:103], v[102:103], v[10:11] op_sel:[0,1] op_sel_hi:[1,1]
    v_pk_mul_f32 v[120:121], v[120:121], v[10:11] op_sel_hi:[1,0]
    v_pk_mul_f32 v[104:105], v[104:105], v[10:11] op_sel:[0,1] op_sel_hi:[1,1]
    v_pk_mul_f32 v[122:123], v[122:123], v[10:11] op_sel_hi:[1,0]
    v_pk_mul_f32 v[106:107], v[106:107], v[10:11] op_sel:[0,1] op_sel_hi:[1,1]
    v_pk_mul_f32 v[124:125], v[124:125], v[10:11] op_sel_hi:[1,0]
    v_pk_mul_f32 v[108:109], v[108:109], v[10:11] op_sel:[0,1] op_sel_hi:[1,1]
    v_pk_mul_f32 v[126:127], v[126:127], v[10:11] op_sel_hi:[1,0]
    v_pk_mul_f32 v[110:111], v[110:111], v[10:11] op_sel:[0,1] op_sel_hi:[1,1]
    v_cvt_pk_bf16_f32 v144, v112, v113
    v_cvt_pk_bf16_f32 v152, v96, v97
    v_cvt_pk_bf16_f32 v145, v114, v115
    v_cvt_pk_bf16_f32 v153, v98, v99
    v_cvt_pk_bf16_f32 v146, v116, v117
    v_cvt_pk_bf16_f32 v154, v100, v101
    v_cvt_pk_bf16_f32 v147, v118, v119
    v_cvt_pk_bf16_f32 v155, v102, v103
    v_cvt_pk_bf16_f32 v148, v120, v121
    v_cvt_pk_bf16_f32 v156, v104, v105
    v_cvt_pk_bf16_f32 v149, v122, v123
    v_cvt_pk_bf16_f32 v157, v106, v107
    v_cvt_pk_bf16_f32 v150, v124, v125
    v_cvt_pk_bf16_f32 v158, v108, v109
    v_cvt_pk_bf16_f32 v151, v126, v127
    v_cvt_pk_bf16_f32 v159, v110, v111
    s_cmp_eq_u32 s60, 1
    s_cbranch_scc1 L_interleave_layers__ssm_conv_h3__linear_hedgehog__prompt_after_53
    s_mov_b32 s60, 1
    v_mfma_f32_32x32x16_bf16 v[160:175], v[144:147], v[224:227], 0
    v_mfma_f32_32x32x16_bf16 v[160:175], v[148:151], v[228:231], v[160:175]
    v_mfma_f32_32x32x16_bf16 v[176:191], v[152:155], v[224:227], 0
    v_mfma_f32_32x32x16_bf16 v[176:191], v[156:159], v[228:231], v[176:191]
    s_nop 9
    v_cvt_pk_bf16_f32 v192, v160, v161
    v_cvt_pk_bf16_f32 v193, v162, v163
    v_cvt_pk_bf16_f32 v194, v164, v165
    v_cvt_pk_bf16_f32 v195, v166, v167
    v_cvt_pk_bf16_f32 v196, v168, v169
    v_cvt_pk_bf16_f32 v197, v170, v171
    v_cvt_pk_bf16_f32 v198, v172, v173
    v_cvt_pk_bf16_f32 v199, v174, v175
    v_mfma_f32_32x32x16_bf16 v[128:143], v[192:195], v[208:211], 0
    s_nop 0
    v_mfma_f32_32x32x16_bf16 v[128:143], v[196:199], v[212:215], v[128:143]
    v_cvt_pk_bf16_f32 v200, v176, v177
    v_cvt_pk_bf16_f32 v201, v178, v179
    v_cvt_pk_bf16_f32 v202, v180, v181
    v_cvt_pk_bf16_f32 v203, v182, v183
    v_cvt_pk_bf16_f32 v204, v184, v185
    v_cvt_pk_bf16_f32 v205, v186, v187
    v_cvt_pk_bf16_f32 v206, v188, v189
    v_cvt_pk_bf16_f32 v207, v190, v191
    v_mfma_f32_32x32x16_bf16 v[80:95], v[200:203], v[208:211], 0
    s_nop 0
    v_mfma_f32_32x32x16_bf16 v[80:95], v[204:207], v[212:215], v[80:95]
    v_pk_add_f32 v[56:57], v[160:161], v[162:163]
    v_pk_add_f32 v[56:57], v[56:57], v[164:165]
    v_pk_add_f32 v[56:57], v[56:57], v[166:167]
    v_pk_add_f32 v[56:57], v[56:57], v[168:169]
    v_pk_add_f32 v[56:57], v[56:57], v[170:171]
    v_pk_add_f32 v[56:57], v[56:57], v[172:173]
    v_pk_add_f32 v[56:57], v[56:57], v[174:175]
    v_add_f32 v56, v56, v57
    v_pk_add_f32 v[58:59], v[176:177], v[178:179]
    v_pk_add_f32 v[58:59], v[58:59], v[180:181]
    v_pk_add_f32 v[58:59], v[58:59], v[182:183]
    v_pk_add_f32 v[58:59], v[58:59], v[184:185]
    v_pk_add_f32 v[58:59], v[58:59], v[186:187]
    v_pk_add_f32 v[58:59], v[58:59], v[188:189]
    v_pk_add_f32 v[58:59], v[58:59], v[190:191]
    v_add_f32 v58, v58, v59
    s_nop 1
    v_permlane32_swap_b32 v56, v58
    v_add_f32 v56, v56, v58
    s_lshl_b32 s45, s40, 13
    s_add_u32 s45, s45, 57344
    v_lshl_add_u32 v3, v2, 4, s45
    s_lshl_b32 s45, s40, 8
    s_add_u32 s45, s45, 49152
    v_lshl_add_u32 v4, v2, 2, s45
    ds_write_b32 v4, v56
    ds_write_b128 v3, v[128:131] offset:0
    ds_write_b128 v3, v[132:135] offset:1024
    ds_write_b128 v3, v[136:139] offset:2048
    ds_write_b128 v3, v[140:143] offset:3072
    ds_write_b128 v3, v[80:83] offset:4096
    ds_write_b128 v3, v[84:87] offset:5120
    ds_write_b128 v3, v[88:91] offset:6144
    ds_write_b128 v3, v[92:95] offset:7168
    s_lshl_b32 s45, s40, 10
    s_add_u32 s45, s45, 57344
    v_lshl_add_u32 v3, v2, 4, s45
    v_lshlrev_b32 v4, 2, v2
    s_waitcnt lgkmcnt(0)
    s_barrier
    ds_read_b128 v[160:163], v3 offset:0
    ds_read_b128 v[164:167], v3 offset:8192
    ds_read_b128 v[168:171], v3 offset:16384
    ds_read_b128 v[172:175], v3 offset:24576
    ds_read_b128 v[176:179], v3 offset:32768
    ds_read_b128 v[180:183], v3 offset:40960
    ds_read_b128 v[184:187], v3 offset:49152
    ds_read_b128 v[188:191], v3 offset:57344
    s_cmp_ge_u32 s40, 4
    s_cbranch_scc0 L_interleave_layers__ssm_conv_h3__linear_hedgehog__prompt_npq_54
    ds_read_b128 v[64:67], v55 offset:0
    ds_read_b128 v[68:71], v55 offset:1024
    ds_read_b128 v[72:75], v55 offset:2048
    ds_read_b128 v[76:79], v55 offset:3072
L_interleave_layers__ssm_conv_h3__linear_hedgehog__prompt_npq_54:
    s_lshl_b32 s45, s39, 3
    s_add_u32 s45, s45, s38
    s_lshl_b32 s46, s45, 12
    s_lshl_b32 s47, s40, 9
    s_add_u32 s46, s46, s47
    v_lshlrev_b32 v5, 3, v2
    s_cmp_eq_u32 s40, 7
    s_cbranch_scc0 L_interleave_layers__ssm_conv_h3__linear_hedgehog__prompt_nz_55
    ds_read_b32 v200, v4 offset:49152
    ds_read_b32 v201, v4 offset:49408
    ds_read_b32 v202, v4 offset:49664
    ds_read_b32 v203, v4 offset:49920
    ds_read_b32 v204, v4 offset:50176
    ds_read_b32 v205, v4 offset:50432
    ds_read_b32 v206, v4 offset:50688
    ds_read_b32 v207, v4 offset:50944
    s_waitcnt lgkmcnt(0)
    v_add_f32 v200, v200, v204
    v_add_f32 v201, v201, v205
    v_add_f32 v202, v202, v206
    v_add_f32 v203, v203, v207
    v_add_f32 v200, v200, v202
    v_add_f32 v201, v201, v203
    v_add_f32 v200, v200, v201
    s_lshl_b32 s47, s45, 8
    s_add_u32 s47, s47, 1048576
    buffer_store_dword v200, v4, s[24:27], s47 offen sc1
L_interleave_layers__ssm_conv_h3__linear_hedgehog__prompt_nz_55:
    s_waitcnt lgkmcnt(0)
    v_pk_add_f32 v[160:161], v[160:161], v[176:177]
    v_pk_add_f32 v[162:163], v[162:163], v[178:179]
    v_pk_add_f32 v[164:165], v[164:165], v[180:181]
    v_pk_add_f32 v[166:167], v[166:167], v[182:183]
    v_pk_add_f32 v[168:169], v[168:169], v[184:185]
    v_pk_add_f32 v[170:171], v[170:171], v[186:187]
    v_pk_add_f32 v[172:173], v[172:173], v[188:189]
    v_pk_add_f32 v[174:175], v[174:175], v[190:191]
    v_pk_add_f32 v[160:161], v[160:161], v[168:169]
    v_pk_add_f32 v[162:163], v[162:163], v[170:171]
    v_pk_add_f32 v[164:165], v[164:165], v[172:173]
    v_pk_add_f32 v[166:167], v[166:167], v[174:175]
    v_pk_add_f32 v[160:161], v[160:161], v[164:165]
    v_pk_add_f32 v[162:163], v[162:163], v[166:167]
    v_cvt_pk_bf16_f32 v160, v160, v161
    v_cvt_pk_bf16_f32 v161, v162, v163
    buffer_store_dwordx2 v[160:161], v5, s[24:27], s46 offen sc1
    v_lshlrev_b32 v5, 4, v2
    s_add_u32 s16, s68, 0x2600000
    s_addc_u32 s17, s69, 0
    s_mov_b32 s18, 0x200000
    s_mov_b32 s19, 0x20000
    s_and_b32 s50, s2, 7
    s_lshr_b32 s50, s50, 2
    s_lshl_b32 s50, s50, 3
    s_lshr_b32 s51, s2, 5
    s_add_u32 s50, s50, s51
    s_lshl_b32 s50, s50, 17
    s_mul_i32 s51, s40, 6144
    s_add_u32 s51, s51, 0
    s_add_u32 s50, s50, s51
    s_mov_b32 m0, s51
    s_nop 0
    buffer_load_dwordx4 v5, s[16:19], s50 offen offset:0 sc1 lds
    buffer_load_dwordx4 v5, s[16:19], s50 offen offset:1024 sc1 lds
    buffer_load_dwordx4 v5, s[16:19], s50 offen offset:2048 sc1 lds
    buffer_load_dwordx4 v5, s[16:19], s50 offen offset:3072 sc1 lds
    s_add_u32 s50, s50, 4096
    s_add_u32 s51, s51, 4096
    s_mov_b32 m0, s51
    s_nop 0
    buffer_load_dwordx4 v5, s[16:19], s50 offen offset:0 sc1 lds
    buffer_load_dwordx4 v5, s[16:19], s50 offen offset:1024 sc1 lds
    v_permlane16_swap_b32 v64, v68
    v_permlane16_swap_b32 v65, v69
    v_permlane16_swap_b32 v66, v70
    v_permlane16_swap_b32 v67, v71
    v_permlane16_swap_b32 v72, v76
    v_permlane16_swap_b32 v73, v77
    v_permlane16_swap_b32 v74, v78
    v_permlane16_swap_b32 v75, v79
    v_permlane32_swap_b32 v64, v68
    v_permlane32_swap_b32 v65, v69
    v_permlane32_swap_b32 v66, v70
    v_permlane32_swap_b32 v67, v71
    v_permlane32_swap_b32 v72, v76
    v_permlane32_swap_b32 v73, v77
    v_permlane32_swap_b32 v74, v78
    v_permlane32_swap_b32 v75, v79
    v_pk_fma_f32 v[96:97], v[16:17], v[52:53], v[64:65] op_sel_hi:[1,0,1] neg_lo:[0,1,0] neg_hi:[0,1,0]
    v_pk_fma_f32 v[98:99], v[18:19], v[52:53], v[66:67] op_sel_hi:[1,0,1] neg_lo:[0,1,0] neg_hi:[0,1,0]
    v_pk_fma_f32 v[100:101], v[20:21], v[52:53], v[68:69] op_sel_hi:[1,0,1] neg_lo:[0,1,0] neg_hi:[0,1,0]
    v_pk_fma_f32 v[102:103], v[22:23], v[52:53], v[70:71] op_sel_hi:[1,0,1] neg_lo:[0,1,0] neg_hi:[0,1,0]
    v_pk_fma_f32 v[104:105], v[24:25], v[52:53], v[72:73] op_sel_hi:[1,0,1] neg_lo:[0,1,0] neg_hi:[0,1,0]
    v_pk_fma_f32 v[106:107], v[26:27], v[52:53], v[74:75] op_sel_hi:[1,0,1] neg_lo:[0,1,0] neg_hi:[0,1,0]
    v_pk_fma_f32 v[108:109], v[28:29], v[52:53], v[76:77] op_sel_hi:[1,0,1] neg_lo:[0,1,0] neg_hi:[0,1,0]
    v_pk_fma_f32 v[110:111], v[30:31], v[52:53], v[78:79] op_sel_hi:[1,0,1] neg_lo:[0,1,0] neg_hi:[0,1,0]
    s_branch L_interleave_layers__ssm_conv_h3__linear_hedgehog__prompt_sm_52
L_interleave_layers__ssm_conv_h3__linear_hedgehog__prompt_after_53:
    s_lshl_b32 s47, s39, 3
    s_lshl_b32 s48, s47, 12
    s_lshl_b32 s50, s40, 9
    s_add_u32 s48, s48, s50
    s_lshl_b32 s49, s47, 8
    s_add_u32 s49, s49, 1048576
    v_lshlrev_b32 v5, 3, v2
    v_lshlrev_b32 v6, 2, v2
    s_mov_b32 s62, 0
L_interleave_layers__ssm_conv_h3__linear_hedgehog__prompt_gl_56:
    s_mov_b32 s51, s48
    buffer_load_dwordx2 v[64:65], v5, s[24:27], s51 offen sc1
    s_add_u32 s51, s51, 4096
    buffer_load_dwordx2 v[66:67], v5, s[24:27], s51 offen sc1
    s_add_u32 s51, s51, 4096
    buffer_load_dwordx2 v[68:69], v5, s[24:27], s51 offen sc1
    s_add_u32 s51, s51, 4096
    buffer_load_dwordx2 v[70:71], v5, s[24:27], s51 offen sc1
    s_add_u32 s51, s51, 4096
    buffer_load_dwordx2 v[72:73], v5, s[24:27], s51 offen sc1
    s_add_u32 s51, s51, 4096
    buffer_load_dwordx2 v[74:75], v5, s[24:27], s51 offen sc1
    s_add_u32 s51, s51, 4096
    buffer_load_dwordx2 v[76:77], v5, s[24:27], s51 offen sc1
    s_add_u32 s51, s51, 4096
    buffer_load_dwordx2 v[78:79], v5, s[24:27], s51 offen sc1
    v_mov_b32 v8, 0
    s_cmp_eq_u32 s40, 7
    s_cbranch_scc0 L_interleave_layers__ssm_conv_h3__linear_hedgehog__prompt_zs_58
    buffer_load_dword v128, v6, s[24:27], s49 offen offset:0 sc1
    buffer_load_dword v129, v6, s[24:27], s49 offen offset:256 sc1
    buffer_load_dword v130, v6, s[24:27], s49 offen offset:512 sc1
    buffer_load_dword v131, v6, s[24:27], s49 offen offset:768 sc1
    buffer_load_dword v132, v6, s[24:27], s49 offen offset:1024 sc1
    buffer_load_dword v133, v6, s[24:27], s49 offen offset:1280 sc1
    buffer_load_dword v134, v6, s[24:27], s49 offen offset:1536 sc1
    buffer_load_dword v135, v6, s[24:27], s49 offen offset:1792 sc1
    s_waitcnt vmcnt(0)
    v_max3_u32 v8, v128, v129, v130
    v_max3_u32 v8, v8, v131, v132
    v_max3_u32 v8, v8, v133, v134
    v_max_u32 v8, v8, v135
L_interleave_layers__ssm_conv_h3__linear_hedgehog__prompt_zs_58:
    s_waitcnt vmcnt(0)
    v_max3_u32 v8, v8, v64, v65
    v_max3_u32 v8, v8, v66, v67
    v_max3_u32 v8, v8, v68, v69
    v_max3_u32 v8, v8, v70, v71
    v_max3_u32 v8, v8, v72, v73
    v_max3_u32 v8, v8, v74, v75
    v_max3_u32 v8, v8, v76, v77
    v_max3_u32 v8, v8, v78, v79
    v_cmp_eq_u32 vcc, -1, v8
    s_nop 4
    s_cbranch_vccz L_interleave_layers__ssm_conv_h3__linear_hedgehog__prompt_gd_57
    s_sleep 1
    s_add_u32 s62, s62, 1
    s_cmp_lt_u32 s62, 0x10000
    s_cbranch_scc1 L_interleave_layers__ssm_conv_h3__linear_hedgehog__prompt_gl_56
L_interleave_layers__ssm_conv_h3__linear_hedgehog__prompt_gd_57:
    s_cmp_eq_u32 s40, 7
    s_cbranch_scc0 L_interleave_layers__ssm_conv_h3__linear_hedgehog__prompt_zt_59
    v_add_f32 v128, v128, v132
    v_add_f32 v129, v129, v133
    v_add_f32 v130, v130, v134
    v_add_f32 v131, v131, v135
    v_add_f32 v128, v128, v130
    v_add_f32 v129, v129, v131
    v_add_f32 v128, v128, v129
    v_cvt_pk_bf16_f32 v128, v128, v128
    v_lshrrev_b32 v7, 4, v2
    v_lshlrev_b32 v7, 5, v7
    v_bfe_u32 v8, v2, 2, 1
    v_lshl_add_u32 v7, v8, 4, v7
    v_and_b32 v8, 3, v2
    v_lshl_add_u32 v7, v8, 1, v7
    v_bfe_u32 v8, v2, 3, 1
    v_lshl_add_u32 v7, v8, 3, v7
    v_add_u32 v7, 142848, v7
    ds_write_b16 v7, v128
L_interleave_layers__ssm_conv_h3__linear_hedgehog__prompt_zt_59:
    s_mov_b32 s50, 0xffff0000
    v_lshlrev_b32 v48, 16, v64
    v_and_b32 v49, s50, v64
    v_lshlrev_b32 v50, 16, v65
    v_and_b32 v51, s50, v65
    v_lshlrev_b32 v8, 16, v66
    v_and_b32 v9, s50, v66
    v_pk_add_f32 v[48:49], v[48:49], v[8:9]
    v_lshlrev_b32 v10, 16, v67
    v_and_b32 v11, s50, v67
    v_pk_add_f32 v[50:51], v[50:51], v[10:11]
    v_lshlrev_b32 v8, 16, v68
    v_and_b32 v9, s50, v68
    v_pk_add_f32 v[48:49], v[48:49], v[8:9]
    v_lshlrev_b32 v10, 16, v69
    v_and_b32 v11, s50, v69
    v_pk_add_f32 v[50:51], v[50:51], v[10:11]
    v_lshlrev_b32 v8, 16, v70
    v_and_b32 v9, s50, v70
    v_pk_add_f32 v[48:49], v[48:49], v[8:9]
    v_lshlrev_b32 v10, 16, v71
    v_and_b32 v11, s50, v71
    v_pk_add_f32 v[50:51], v[50:51], v[10:11]
    v_lshlrev_b32 v8, 16, v72
    v_and_b32 v9, s50, v72
    v_pk_add_f32 v[48:49], v[48:49], v[8:9]
    v_lshlrev_b32 v10, 16, v73
    v_and_b32 v11, s50, v73
    v_pk_add_f32 v[50:51], v[50:51], v[10:11]
    v_lshlrev_b32 v8, 16, v74
    v_and_b32 v9, s50, v74
    v_pk_add_f32 v[48:49], v[48:49], v[8:9]
    v_lshlrev_b32 v10, 16, v75
    v_and_b32 v11, s50, v75
    v_pk_add_f32 v[50:51], v[50:51], v[10:11]
    v_lshlrev_b32 v8, 16, v76
    v_and_b32 v9, s50, v76
    v_pk_add_f32 v[48:49], v[48:49], v[8:9]
    v_lshlrev_b32 v10, 16, v77
    v_and_b32 v11, s50, v77
    v_pk_add_f32 v[50:51], v[50:51], v[10:11]
    v_lshlrev_b32 v8, 16, v78
    v_and_b32 v9, s50, v78
    v_pk_add_f32 v[48:49], v[48:49], v[8:9]
    v_lshlrev_b32 v10, 16, v79
    v_and_b32 v11, s50, v79
    v_pk_add_f32 v[50:51], v[50:51], v[10:11]
    v_cvt_pk_bf16_f32 v8, v48, v49
    v_cvt_pk_bf16_f32 v9, v50, v51
    s_lshr_b32 s48, s40, 1
    s_lshl_b32 s48, s48, 10
    s_and_b32 s50, s40, 1
    s_lshl_b32 s50, s50, 3
    s_add_u32 s48, s48, s50
    s_add_u32 s48, s48, 138752
    v_lshl_add_u32 v7, v2, 4, s48
    ds_write_b64 v7, v[8:9]
    s_waitcnt lgkmcnt(0)
    s_barrier
    v_lshlrev_b32 v5, 4, v2
    s_add_u32 s16, s68, 0x2600000
    s_addc_u32 s17, s69, 0
    s_mov_b32 s18, 0x200000
    s_mov_b32 s19, 0x20000
    s_and_b32 s50, s2, 7
    s_lshr_b32 s50, s50, 2
    s_lshl_b32 s50, s50, 3
    s_lshr_b32 s51, s2, 5
    s_add_u32 s50, s50, s51
    s_lshl_b32 s50, s50, 17
    s_mul_i32 s51, s40, 5120
    s_add_u32 s51, s51, 49152
    s_add_u32 s50, s50, s51
    s_mov_b32 m0, s51
    s_nop 0
    buffer_load_dwordx4 v5, s[16:19], s50 offen offset:0 sc1 lds
    buffer_load_dwordx4 v5, s[16:19], s50 offen offset:1024 sc1 lds
    buffer_load_dwordx4 v5, s[16:19], s50 offen offset:2048 sc1 lds
    buffer_load_dwordx4 v5, s[16:19], s50 offen offset:3072 sc1 lds
    s_add_u32 s50, s50, 4096
    s_add_u32 s51, s51, 4096
    s_mov_b32 m0, s51
    s_nop 0
    buffer_load_dwordx4 v5, s[16:19], s50 offen offset:0 sc1 lds
    v_lshlrev_b32 v5, 4, v2
    v_add_u32 v6, 138752, v5
    ds_read_b128 v[64:67], v6 offset:0
    ds_read_b128 v[68:71], v6 offset:1024
    ds_read_b128 v[72:75], v6 offset:2048
    ds_read_b128 v[76:79], v6 offset:3072
    v_lshrrev_b32 v8, 5, v2
    v_lshlrev_b32 v8, 4, v8
    v_add_u32 v8, 142848, v8
    ds_read_b128 v[80:83], v8 offset:0
    ds_read_b128 v[84:87], v8 offset:32
    ds_read_b128 v[88:91], v8 offset:64
    ds_read_b128 v[92:95], v8 offset:96
    s_lshl_b32 s46, s38, 3
    s_add_u32 s46, s46, s43
    s_lshl_b32 s46, s46, 16
    s_lshl_b32 s47, s39, 11
    s_add_u32 s46, s46, s47
    s_waitcnt lgkmcnt(7)
    v_mfma_f32_32x32x16_bf16 v[96:111], v[64:67], v[144:147], 0
    s_waitcnt lgkmcnt(6)
    v_mfma_f32_32x32x16_bf16 v[96:111], v[68:71], v[148:151], v[96:111]
    s_waitcnt lgkmcnt(5)
    v_mfma_f32_32x32x16_bf16 v[96:111], v[72:75], v[152:155], v[96:111]
    s_waitcnt lgkmcnt(4)
    v_mfma_f32_32x32x16_bf16 v[96:111], v[76:79], v[156:159], v[96:111]
    s_waitcnt lgkmcnt(3)
    v_mfma_f32_32x32x16_bf16 v[112:127], v[80:83], v[144:147], 0
    s_waitcnt lgkmcnt(2)
    v_mfma_f32_32x32x16_bf16 v[112:127], v[84:87], v[148:151], v[112:127]
    s_waitcnt lgkmcnt(1)
    v_mfma_f32_32x32x16_bf16 v[112:127], v[88:91], v[152:155], v[112:127]
    s_waitcnt lgkmcnt(0)
    v_mfma_f32_32x32x16_bf16 v[112:127], v[92:95], v[156:159], v[112:127]
    s_nop 11
    v_add_f32 v8, 0x358637bd, v112
    v_rcp_f32 v8, v8
    s_nop 0
    v_pk_mul_f32 v[96:97], v[96:97], v[8:9] op_sel_hi:[1,0]
    v_pk_mul_f32 v[98:99], v[98:99], v[8:9] op_sel_hi:[1,0]
    v_pk_mul_f32 v[100:101], v[100:101], v[8:9] op_sel_hi:[1,0]
    v_pk_mul_f32 v[102:103], v[102:103], v[8:9] op_sel_hi:[1,0]
    v_pk_mul_f32 v[104:105], v[104:105], v[8:9] op_sel_hi:[1,0]
    v_pk_mul_f32 v[106:107], v[106:107], v[8:9] op_sel_hi:[1,0]
    v_pk_mul_f32 v[108:109], v[108:109], v[8:9] op_sel_hi:[1,0]
    v_pk_mul_f32 v[110:111], v[110:111], v[8:9] op_sel_hi:[1,0]
    v_cvt_pk_bf16_f32 v128, v96, v97
    v_cvt_pk_bf16_f32 v129, v98, v99
    v_cvt_pk_bf16_f32 v130, v100, v101
    v_cvt_pk_bf16_f32 v131, v102, v103
    v_cvt_pk_bf16_f32 v132, v104, v105
    v_cvt_pk_bf16_f32 v133, v106, v107
    v_cvt_pk_bf16_f32 v134, v108, v109
    v_cvt_pk_bf16_f32 v135, v110, v111
    buffer_store_dwordx4 v[128:131], v5, s[32:35], s46 offen offset:0 sc1
    buffer_store_dwordx4 v[132:135], v5, s[32:35], s46 offen offset:1024 sc1
    s_waitcnt vmcnt(0)
    s_barrier
    s_mul_i32 s36, s71, 98304
    s_lshl_b32 s37, s38, 12
    s_add_u32 s36, s36, s37
    s_lshl_b32 s37, s39, 7
    s_add_u32 s36, s36, s37
    s_add_u32 s36, s36, 98304
    s_cmp_eq_u32 s70, 0
    s_cbranch_scc0 L_interleave_layers__ssm_conv_h3__linear_hedgehog__prompt_sf_60
    v_mov_b32 v253, 0
    v_mov_b32 v254, s73
    s_mov_b64 exec, 1
    buffer_store_dword v254, v253, s[64:67], s36 offen sc1
    s_mov_b64 exec, -1
L_interleave_layers__ssm_conv_h3__linear_hedgehog__prompt_sf_60:
    s_cmp_eq_u32 s40, 4
    s_cbranch_scc1 L_interleave_layers__ssm_conv_h3__linear_hedgehog__prompt_nb2_61
    s_cmp_gt_u32 s40, 4
    s_cselect_b32 s52, 1, 0
    s_sub_u32 s52, s40, s52
    s_add_u32 s16, s68, 0x2600000
    s_addc_u32 s17, s69, 0
    s_mov_b32 s18, 0x200000
    s_mov_b32 s19, 0x20000
    s_and_b32 s50, s2, 7
    s_lshr_b32 s50, s50, 2
    s_lshl_b32 s50, s50, 3
    s_lshr_b32 s51, s2, 5
    s_add_u32 s50, s50, s51
    s_lshl_b32 s50, s50, 17
    s_mul_i32 s51, s52, 6144
    s_add_u32 s51, s51, 90112
    s_add_u32 s50, s50, s51
    s_mov_b32 m0, s51
    s_nop 0
    buffer_load_dwordx4 v5, s[16:19], s50 offen offset:0 sc1 lds
    buffer_load_dwordx4 v5, s[16:19], s50 offen offset:1024 sc1 lds
    buffer_load_dwordx4 v5, s[16:19], s50 offen offset:2048 sc1 lds
    buffer_load_dwordx4 v5, s[16:19], s50 offen offset:3072 sc1 lds
    s_add_u32 s50, s50, 4096
    s_add_u32 s51, s51, 4096
    s_mov_b32 m0, s51
    s_nop 0
    buffer_load_dwordx4 v5, s[16:19], s50 offen offset:0 sc1 lds
    buffer_load_dwordx4 v5, s[16:19], s50 offen offset:1024 sc1 lds
L_interleave_layers__ssm_conv_h3__linear_hedgehog__prompt_nb2_61:
    s_load_dwordx2 s[6:7], s[0:1], 80
    s_and_b32 s36, s2, 7
    s_lshr_b32 s37, s2, 3
    s_and_b32 s38, s36, 3
    s_lshl_b32 s38, s38, 2
    s_and_b32 s39, s37, 3
    s_add_u32 s38, s38, s39
    s_lshr_b32 s39, s36, 2
    s_lshl_b32 s39, s39, 3
    s_lshr_b32 s41, s37, 2
    s_add_u32 s39, s39, s41
    v_and_b32 v2, 63, v0
    v_lshrrev_b32 v3, 4, v2
    v_lshlrev_b32 v3, 2, v3
    v_and_b32 v7, 3, v2
    v_add_u32 v3, v3, v7
    s_lshl_b32 s41, s70, 4
    v_add_u32 v3, s41, v3
    v_bfe_u32 v7, v2, 2, 2
    v_mul_u32_u24 v6, 272, v3
    v_lshl_add_u32 v6, v7, 6, v6
    v_lshlrev_b32 v5, 3, v3
    s_lshl_b32 s41, s38, 7
    v_add_u32 v3, s41, v3
    v_lshlrev_b32 v4, 11, v3
    v_lshl_add_u32 v4, v7, 5, v4
    s_lshl_b32 s41, s39, 7
    v_add_u32 v4, s41, v4
    s_mov_b32 s40, s70
    s_mul_i32 s14, s71, 0x2800000
    s_add_u32 s14, s14, 0x1000000
    s_add_u32 s12, s68, s14
    s_addc_u32 s13, s69, 0
    s_mov_b32 s14, 0x400000
    s_mov_b32 s15, 0x20000
    s_and_b32 s43, s40, 3
    s_lshr_b32 s44, s40, 2
    s_lshl_b32 s45, s38, 2
    s_add_u32 s45, s45, s43
    s_lshl_b32 s53, s45, 16
    s_lshl_b32 s45, s44, 15
    s_add_u32 s53, s53, s45
    v_lshlrev_b32 v8, 4, v2
    s_lshl_b32 s45, s44, 16
    v_add_u32 v9, s45, v8
    v_mov_b32 v64, 0
    v_mov_b32 v65, 0
    v_mov_b32 v66, 0
    v_mov_b32 v67, 0
    v_mov_b32 v68, 0
    v_mov_b32 v69, 0
    v_mov_b32 v70, 0
    v_mov_b32 v71, 0
    v_mov_b32 v72, 0
    v_mov_b32 v73, 0
    v_mov_b32 v74, 0
    v_mov_b32 v75, 0
    v_mov_b32 v76, 0
    v_mov_b32 v77, 0
    v_mov_b32 v78, 0
    v_mov_b32 v79, 0
    v_mov_b32 v80, 0
    v_mov_b32 v81, 0
    v_mov_b32 v82, 0
    v_mov_b32 v83, 0
    v_mov_b32 v84, 0
    v_mov_b32 v85, 0
    v_mov_b32 v86, 0
    v_mov_b32 v87, 0
    v_mov_b32 v88, 0
    v_mov_b32 v89, 0
    v_mov_b32 v90, 0
    v_mov_b32 v91, 0
    v_mov_b32 v92, 0
    v_mov_b32 v93, 0
    v_mov_b32 v94, 0
    v_mov_b32 v95, 0
    s_waitcnt lgkmcnt(0)
    s_mov_b32 s24, s6
    s_mov_b32 s25, s7
    s_mov_b32 s26, 0x400000
    s_mov_b32 s27, 0x20000
    s_mul_i32 s45, s71, 98304
    s_lshr_b32 s46, s38, 1
    s_lshl_b32 s46, s46, 12
    s_add_u32 s45, s45, s46
    s_add_u32 s45, s45, 98304
    s_cmp_eq_u32 s70, 4
    s_cbranch_scc0 L_interleave_layers__ssm_conv_h3__linear_hedgehog__prompt_np_62
    v_and_b32 v253, 63, v0
    v_lshlrev_b32 v253, 7, v253
    s_mov_b32 exec_lo, 0xffffffff
    s_mov_b32 exec_hi, 0
    s_mov_b32 s62, 0
L_interleave_layers__ssm_conv_h3__linear_hedgehog__prompt_pl_63:
    buffer_load_dword v248, v253, s[64:67], s45 offen sc1
    s_waitcnt vmcnt(0)
    v_cmp_eq_u32 vcc, s73, v248
    s_nop 3
    s_cmp_eq_u64 vcc, exec
    s_cbranch_scc1 L_interleave_layers__ssm_conv_h3__linear_hedgehog__prompt_pd_64
    s_sleep 1
    s_add_u32 s62, s62, 1
    s_cmp_lt_u32 s62, 0x10000
    s_cbranch_scc1 L_interleave_layers__ssm_conv_h3__linear_hedgehog__prompt_pl_63
L_interleave_layers__ssm_conv_h3__linear_hedgehog__prompt_pd_64:
    s_mov_b64 exec, -1
L_interleave_layers__ssm_conv_h3__linear_hedgehog__prompt_np_62:
    s_waitcnt vmcnt(0)
    s_barrier
    buffer_load_dwordx4 v[96:99], v8, s[12:15], s53 offen offset:0 sc1
    buffer_load_dwordx4 v[100:103], v8, s[12:15], s53 offen offset:1024 sc1
    buffer_load_dwordx4 v[104:107], v8, s[12:15], s53 offen offset:2048 sc1
    buffer_load_dwordx4 v[108:111], v8, s[12:15], s53 offen offset:3072 sc1
    s_add_u32 s53, s53, 4096
    buffer_load_dwordx4 v[112:115], v8, s[12:15], s53 offen offset:0 sc1
    buffer_load_dwordx4 v[116:119], v8, s[12:15], s53 offen offset:1024 sc1
    buffer_load_dwordx4 v[120:123], v8, s[12:15], s53 offen offset:2048 sc1
    buffer_load_dwordx4 v[124:127], v8, s[12:15], s53 offen offset:3072 sc1
    s_add_u32 s53, s53, 4096
    ds_read_b128 v[128:131], v9 offset:0
    ds_read_b128 v[132:135], v9 offset:1024
    ds_read_b128 v[136:139], v9 offset:2048
    ds_read_b128 v[140:143], v9 offset:3072
    ds_read_b128 v[144:147], v9 offset:4096
    ds_read_b128 v[148:151], v9 offset:5120
    s_mov_b32 s46, 0
L_interleave_layers__ssm_conv_h3__linear_hedgehog__prompt_oloop_65:
    ds_read_b128 v[152:155], v9 offset:6144
    ds_read_b128 v[156:159], v9 offset:7168
    s_waitcnt vmcnt(7)
    s_waitcnt lgkmcnt(6)
    v_mfma_f32_32x32x16_bf16 v[64:79], v[128:131], v[96:99], v[64:79]
    v_mfma_f32_32x32x16_bf16 v[80:95], v[132:135], v[96:99], v[80:95]
    buffer_load_dwordx4 v[96:99], v8, s[12:15], s53 offen offset:0 sc1
    ds_read_b128 v[128:131], v9 offset:8192
    ds_read_b128 v[132:135], v9 offset:9216
    s_waitcnt vmcnt(7)
    s_waitcnt lgkmcnt(6)
    v_mfma_f32_32x32x16_bf16 v[64:79], v[136:139], v[100:103], v[64:79]
    v_mfma_f32_32x32x16_bf16 v[80:95], v[140:143], v[100:103], v[80:95]
    buffer_load_dwordx4 v[100:103], v8, s[12:15], s53 offen offset:1024 sc1
    ds_read_b128 v[136:139], v9 offset:10240
    ds_read_b128 v[140:143], v9 offset:11264
    s_waitcnt vmcnt(7)
    s_waitcnt lgkmcnt(6)
    v_mfma_f32_32x32x16_bf16 v[64:79], v[144:147], v[104:107], v[64:79]
    v_mfma_f32_32x32x16_bf16 v[80:95], v[148:151], v[104:107], v[80:95]
    buffer_load_dwordx4 v[104:107], v8, s[12:15], s53 offen offset:2048 sc1
    ds_read_b128 v[144:147], v9 offset:12288
    ds_read_b128 v[148:151], v9 offset:13312
    s_waitcnt vmcnt(7)
    s_waitcnt lgkmcnt(6)
    v_mfma_f32_32x32x16_bf16 v[64:79], v[152:155], v[108:111], v[64:79]
    v_mfma_f32_32x32x16_bf16 v[80:95], v[156:159], v[108:111], v[80:95]
    buffer_load_dwordx4 v[108:111], v8, s[12:15], s53 offen offset:3072 sc1
    s_add_u32 s53, s53, 4096
    ds_read_b128 v[152:155], v9 offset:14336
    ds_read_b128 v[156:159], v9 offset:15360
    s_waitcnt vmcnt(7)
    s_waitcnt lgkmcnt(6)
    v_mfma_f32_32x32x16_bf16 v[64:79], v[128:131], v[112:115], v[64:79]
    v_mfma_f32_32x32x16_bf16 v[80:95], v[132:135], v[112:115], v[80:95]
    buffer_load_dwordx4 v[112:115], v8, s[12:15], s53 offen offset:0 sc1
    ds_read_b128 v[128:131], v9 offset:16384
    ds_read_b128 v[132:135], v9 offset:17408
    s_waitcnt vmcnt(7)
    s_waitcnt lgkmcnt(6)
    v_mfma_f32_32x32x16_bf16 v[64:79], v[136:139], v[116:119], v[64:79]
    v_mfma_f32_32x32x16_bf16 v[80:95], v[140:143], v[116:119], v[80:95]
    buffer_load_dwordx4 v[116:119], v8, s[12:15], s53 offen offset:1024 sc1
    ds_read_b128 v[136:139], v9 offset:18432
    ds_read_b128 v[140:143], v9 offset:19456
    s_waitcnt vmcnt(7)
    s_waitcnt lgkmcnt(6)
    v_mfma_f32_32x32x16_bf16 v[64:79], v[144:147], v[120:123], v[64:79]
    v_mfma_f32_32x32x16_bf16 v[80:95], v[148:151], v[120:123], v[80:95]
    buffer_load_dwordx4 v[120:123], v8, s[12:15], s53 offen offset:2048 sc1
    ds_read_b128 v[144:147], v9 offset:20480
    ds_read_b128 v[148:151], v9 offset:21504
    s_waitcnt vmcnt(7)
    s_waitcnt lgkmcnt(6)
    v_mfma_f32_32x32x16_bf16 v[64:79], v[152:155], v[124:127], v[64:79]
    v_mfma_f32_32x32x16_bf16 v[80:95], v[156:159], v[124:127], v[80:95]
    buffer_load_dwordx4 v[124:127], v8, s[12:15], s53 offen offset:3072 sc1
    s_add_u32 s53, s53, 4096
    v_add_u32 v9, 16384, v9
    s_add_u32 s46, s46, 1
    s_cmp_lt_u32 s46, 3
    s_cbranch_scc1 L_interleave_layers__ssm_conv_h3__linear_hedgehog__prompt_oloop_65
    s_barrier
    ds_read_b128 v[152:155], v9 offset:6144
    ds_read_b128 v[156:159], v9 offset:7168
    s_waitcnt vmcnt(7)
    s_waitcnt lgkmcnt(6)
    v_mfma_f32_32x32x16_bf16 v[64:79], v[128:131], v[96:99], v[64:79]
    v_mfma_f32_32x32x16_bf16 v[80:95], v[132:135], v[96:99], v[80:95]
    ds_read_b128 v[128:131], v9 offset:8192
    ds_read_b128 v[132:135], v9 offset:9216
    s_waitcnt vmcnt(6)
    s_waitcnt lgkmcnt(6)
    v_mfma_f32_32x32x16_bf16 v[64:79], v[136:139], v[100:103], v[64:79]
    v_mfma_f32_32x32x16_bf16 v[80:95], v[140:143], v[100:103], v[80:95]
    ds_read_b128 v[136:139], v9 offset:10240
    ds_read_b128 v[140:143], v9 offset:11264
    s_waitcnt vmcnt(5)
    s_waitcnt lgkmcnt(6)
    v_mfma_f32_32x32x16_bf16 v[64:79], v[144:147], v[104:107], v[64:79]
    v_mfma_f32_32x32x16_bf16 v[80:95], v[148:151], v[104:107], v[80:95]
    ds_read_b128 v[144:147], v9 offset:12288
    ds_read_b128 v[148:151], v9 offset:13312
    s_waitcnt vmcnt(4)
    s_waitcnt lgkmcnt(6)
    v_mfma_f32_32x32x16_bf16 v[64:79], v[152:155], v[108:111], v[64:79]
    v_mfma_f32_32x32x16_bf16 v[80:95], v[156:159], v[108:111], v[80:95]
    ds_read_b128 v[152:155], v9 offset:14336
    ds_read_b128 v[156:159], v9 offset:15360
    s_waitcnt vmcnt(3)
    s_waitcnt lgkmcnt(6)
    v_mfma_f32_32x32x16_bf16 v[64:79], v[128:131], v[112:115], v[64:79]
    v_mfma_f32_32x32x16_bf16 v[80:95], v[132:135], v[112:115], v[80:95]
    s_waitcnt vmcnt(2)
    s_waitcnt lgkmcnt(4)
    v_mfma_f32_32x32x16_bf16 v[64:79], v[136:139], v[116:119], v[64:79]
    v_mfma_f32_32x32x16_bf16 v[80:95], v[140:143], v[116:119], v[80:95]
    s_waitcnt vmcnt(1)
    s_waitcnt lgkmcnt(2)
    v_mfma_f32_32x32x16_bf16 v[64:79], v[144:147], v[120:123], v[64:79]
    v_mfma_f32_32x32x16_bf16 v[80:95], v[148:151], v[120:123], v[80:95]
    s_waitcnt vmcnt(0)
    s_waitcnt lgkmcnt(0)
    v_mfma_f32_32x32x16_bf16 v[64:79], v[152:155], v[124:127], v[64:79]
    v_mfma_f32_32x32x16_bf16 v[80:95], v[156:159], v[124:127], v[80:95]
    v_and_b32 v3, 31, v2
    s_lshl_b32 s45, s43, 5
    v_add_u32 v3, s45, v3
    v_mul_u32_u24 v3, 272, v3
    v_lshrrev_b32 v10, 5, v2
    v_lshl_add_u32 v3, v10, 4, v3
    s_lshl_b32 s45, s44, 16
    v_add_u32 v3, s45, v3
    s_nop 2
    ds_write_b128 v3, v[64:67] offset:0
    ds_write_b128 v3, v[68:71] offset:32
    ds_write_b128 v3, v[72:75] offset:64
    ds_write_b128 v3, v[76:79] offset:96
    ds_write_b128 v3, v[80:83] offset:128
    ds_write_b128 v3, v[84:87] offset:160
    ds_write_b128 v3, v[88:91] offset:192
    ds_write_b128 v3, v[92:95] offset:224
    s_waitcnt lgkmcnt(0)
    s_barrier
    ds_read_b128 v[32:35], v6 offset:0
    ds_read_b128 v[36:39], v6 offset:16
    ds_read_b128 v[40:43], v6 offset:32
    ds_read_b128 v[44:47], v6 offset:48
    v_add_u32 v7, 65536, v6
    ds_read_b128 v[48:51], v7 offset:0
    ds_read_b128 v[52:55], v7 offset:16
    ds_read_b128 v[56:59], v7 offset:32
    ds_read_b128 v[60:63], v7 offset:48
    s_mov_b32 s40, 0xffff0000
    v_lshlrev_b32 v16, 16, v232
    v_and_b32 v17, s40, v232
    v_lshlrev_b32 v18, 16, v233
    v_and_b32 v19, s40, v233
    v_lshlrev_b32 v20, 16, v234
    v_and_b32 v21, s40, v234
    v_lshlrev_b32 v22, 16, v235
    v_and_b32 v23, s40, v235
    v_lshlrev_b32 v24, 16, v236
    v_and_b32 v25, s40, v236
    v_lshlrev_b32 v26, 16, v237
    v_and_b32 v27, s40, v237
    v_lshlrev_b32 v28, 16, v238
    v_and_b32 v29, s40, v238
    v_lshlrev_b32 v30, 16, v239
    v_and_b32 v31, s40, v239
    s_waitcnt lgkmcnt(7)
    v_pk_add_f32 v[16:17], v[16:17], v[32:33]
    v_pk_add_f32 v[18:19], v[18:19], v[34:35]
    s_waitcnt lgkmcnt(6)
    v_pk_add_f32 v[20:21], v[20:21], v[36:37]
    v_pk_add_f32 v[22:23], v[22:23], v[38:39]
    s_waitcnt lgkmcnt(5)
    v_pk_add_f32 v[24:25], v[24:25], v[40:41]
    v_pk_add_f32 v[26:27], v[26:27], v[42:43]
    s_waitcnt lgkmcnt(4)
    v_pk_add_f32 v[28:29], v[28:29], v[44:45]
    v_pk_add_f32 v[30:31], v[30:31], v[46:47]
    s_waitcnt lgkmcnt(3)
    v_pk_add_f32 v[16:17], v[16:17], v[48:49]
    v_pk_add_f32 v[18:19], v[18:19], v[50:51]
    s_waitcnt lgkmcnt(2)
    v_pk_add_f32 v[20:21], v[20:21], v[52:53]
    v_pk_add_f32 v[22:23], v[22:23], v[54:55]
    s_waitcnt lgkmcnt(1)
    v_pk_add_f32 v[24:25], v[24:25], v[56:57]
    v_pk_add_f32 v[26:27], v[26:27], v[58:59]
    s_waitcnt lgkmcnt(0)
    v_pk_add_f32 v[28:29], v[28:29], v[60:61]
    v_pk_add_f32 v[30:31], v[30:31], v[62:63]
    v_cvt_pk_bf16_f32 v232, v16, v17
    v_cvt_pk_bf16_f32 v233, v18, v19
    v_cvt_pk_bf16_f32 v234, v20, v21
    v_cvt_pk_bf16_f32 v235, v22, v23
    v_cvt_pk_bf16_f32 v236, v24, v25
    v_cvt_pk_bf16_f32 v237, v26, v27
    v_cvt_pk_bf16_f32 v238, v28, v29
    v_cvt_pk_bf16_f32 v239, v30, v31
    s_cmp_eq_u32 s71, 0
    s_cbranch_scc1 L_interleave_layers__ssm_conv_h3__linear_hedgehog__prompt_lx_66
    s_lshl_b32 s47, s70, 11
    s_add_u32 s47, s47, 102400
    v_lshrrev_b32 v8, 4, v2
    v_lshlrev_b32 v8, 2, v8
    v_and_b32 v9, 3, v2
    v_add_u32 v8, v8, v9
    v_lshlrev_b32 v8, 7, v8
    v_bfe_u32 v9, v2, 2, 2
    v_lshl_add_u32 v8, v9, 5, v8
    v_add_u32 v8, s47, v8
    ds_write_b64 v8, v[232:233] offset:0
    ds_write_b64 v8, v[234:235] offset:8
    ds_write_b64 v8, v[236:237] offset:16
    ds_write_b64 v8, v[238:239] offset:24
    v_lshl_add_u32 v9, v2, 4, s47
    s_lshl_b32 s45, s38, 3
    s_add_u32 s45, s45, s70
    s_lshl_b32 s45, s45, 15
    s_lshl_b32 s46, s39, 7
    s_add_u32 s45, s45, s46
    s_add_u32 s46, s45, 16384
    v_lshrrev_b32 v10, 3, v2
    v_lshlrev_b32 v10, 11, v10
    v_and_b32 v11, 7, v2
    v_lshl_add_u32 v10, v11, 4, v10
    s_waitcnt lgkmcnt(0)
    ds_read_b128 v[48:51], v9
    ds_read_b128 v[52:55], v9 offset:1024
    s_waitcnt lgkmcnt(1)
    buffer_store_dwordx4 v[48:51], v10, s[24:27], s45 offen sc1
    s_waitcnt lgkmcnt(0)
    buffer_store_dwordx4 v[52:55], v10, s[24:27], s46 offen sc1
L_interleave_layers__ssm_conv_h3__linear_hedgehog__prompt_lx_66:
    s_cmp_eq_u32 s71, 1
    s_cbranch_scc1 L_interleave_layers__ssm_conv_h3__linear_hedgehog__prompt_fin_67
    s_mov_b32 s71, 1
    s_branch L_interleave_layers__ssm_conv_h3__linear_hedgehog__prompt_layer_20
L_interleave_layers__ssm_conv_h3__linear_hedgehog__prompt_fin_67:
    s_cmp_eq_u32 s2, 0
    s_cbranch_scc0 L_interleave_layers__ssm_conv_h3__linear_hedgehog__prompt_nw_68
    s_cmp_eq_u32 s70, 0
    s_cbranch_scc0 L_interleave_layers__ssm_conv_h3__linear_hedgehog__prompt_nw_68
    s_add_u32 s8, s68, 0x2880000
    s_addc_u32 s9, s69, 0
    s_mov_b32 s10, 0x100
    s_mov_b32 s11, 0x20000
    v_mov_b32 v3, 0
    v_mov_b32 v4, s73
    s_mov_b64 exec, 1
    buffer_store_dword v4, v3, s[8:11], 0 offen
    s_mov_b64 exec, -1
L_interleave_layers__ssm_conv_h3__linear_hedgehog__prompt_nw_68:
L_interleave_layers__ssm_conv_h3__linear_hedgehog__prompt_end_1:
    s_endpgm
L_code_end:
    s_endpgm
.section .rodata,"a"
.p2align 6
.amdhsa_kernel interleave_layers__ssm_conv_h3__linear_kernel_hedgehog__prompt_kernel
  .amdhsa_next_free_vgpr 256
  .amdhsa_next_free_sgpr 96
  .amdhsa_accum_offset 256
  .amdhsa_group_segment_fixed_size 0
  .amdhsa_kernarg_size 104
  .amdhsa_user_sgpr_count 2
  .amdhsa_user_sgpr_kernarg_segment_ptr 1
  .amdhsa_system_sgpr_workgroup_id_x 1
.end_amdhsa_kernel
```
